```python
import torch

def _softmax(x, axis=-1):
    return torch.softmax(x, dim=axis)
def _gelu(x):
    return torch.nn.functional.gelu(x, approximate="tanh")
def _silu(x):
    return torch.nn.functional.silu(x)
def _sigmoid(x):
    return torch.sigmoid(x)
def _layernorm(x, axis=-1, eps=1e-5):
    m = x.mean(dim=axis, keepdim=True)
    v = x.var(dim=axis, keepdim=True, unbiased=False)
    return (x - m) / torch.sqrt(v + eps)
def _scatter_add(tgt, idx, src, axis=0):
    return tgt.clone().index_add_(axis, idx, src)
def _segment_sum(src, seg, n):
    out = torch.zeros((n,) + src.shape[1:], dtype=src.dtype)
    return out.index_add_(0, seg, src)
def _pad(x, pw):
    flat = tuple(v for pair in reversed(pw) for v in pair)
    return torch.nn.functional.pad(x, flat)

kernel_name = 'gated_mix__linear_kernel_hedgehog__dense_activation_mish__prompt'

def setup_inputs():

    _w = (lambda a: (lambda t: t.to(torch.bfloat16) if t.is_floating_point() else t)(torch.as_tensor(a)))
    def _A_setup():
        B, S, D, H = 1, 2048, 448, 16
        Dh = D // H
        return {
            "x": _w((lambda *s: torch.randn(*s, dtype=torch.bfloat16) * 0.05)(B, S, D)),
            "wqkv": _w((lambda *s: torch.randn(*s, dtype=torch.bfloat16) * 0.8)(D, 3 * D)),
            "w_phi": _w((lambda *s: torch.randn(*s, dtype=torch.bfloat16) * 0.8)(H, Dh, Dh) * (Dh ** -0.5)),
            "wo": _w((lambda *s: torch.randn(*s, dtype=torch.bfloat16) * 0.05)(D, D)),
        }
    _A_in = _A_setup()

    def _B_setup():
        B, S, D, F = 1, 2048, 448, 1792
        return {
            "x": _w((lambda *s: torch.randn(*s, dtype=torch.bfloat16) * 0.05)(B, S, D)),
            "w1": _w((lambda *s: torch.randn(*s, dtype=torch.bfloat16) * 6.4)(D, F) * (D ** -0.5)),
            "b1": _w((lambda *s: torch.randn(*s, dtype=torch.bfloat16) * 0.1)(F)),
            "w2": _w((lambda *s: torch.randn(*s, dtype=torch.bfloat16) * 0.1)(F, D) * (F ** -0.5)),
        }
    _B_in = _B_setup()

    return {
        "A_x": _A_in["x"],
        "A_wqkv": _A_in["wqkv"],
        "A_w_phi": _A_in["w_phi"],
        "A_wo": _A_in["wo"],
        "B_x": _B_in["x"],
        "B_w1": _B_in["w1"],
        "B_b1": _B_in["b1"],
        "B_w2": _B_in["w2"],
        "gate_w": _w((lambda *s: torch.randn(*s, dtype=torch.bfloat16) * 0.05)(448) * 16.0),
    }

def reference(A_x, A_wqkv, A_w_phi, A_wo, B_x, B_w1, B_b1, B_w2, gate_w):
    def _A_ref(x, wqkv, w_phi, wo):
        B, S, D = x.shape
        H = 16; Dh = D // H
        qkv = (lambda x, *d: x.permute(*d))((x @ wqkv).reshape(B, S, 3, H, Dh), 2, 0, 3, 1, 4)
        q, k, v = qkv[0], qkv[1], qkv[2]
        pq = torch.einsum("bhsd,hdf->bhsf", q, w_phi)
        pk = torch.einsum("bhsd,hdf->bhsf", k, w_phi)
        phi_q = torch.concatenate([_softmax(pq, axis=-1), _softmax(-pq, axis=-1)], axis=-1)
        phi_k = torch.concatenate([_softmax(pk, axis=-1), _softmax(-pk, axis=-1)], axis=-1)
        kv = torch.einsum("bhsf,bhsd->bhfd", phi_k, v)
        z  = torch.einsum("bhsf->bhf", phi_k)
        num = torch.einsum("bhqf,bhfd->bhqd", phi_q, kv)
        den = torch.einsum("bhqf,bhf->bhq", phi_q, z)[..., None] + 1e-6
        o = num / den
        return (lambda x, *d: x.permute(*d))(o, 0, 2, 1, 3).reshape(B, S, D) @ wo

    def _B_ref(x, w1, b1, w2):
        h = torch.einsum("bsd,df->bsf", x, w1) + b1
        sp = torch.log1p(torch.exp(-torch.abs(h))) + torch.where(h > 0, h, torch.zeros_like(h))
        act = h * torch.tanh(sp)
        return torch.einsum("bsf,fd->bsd", act, w2)

    x = A_x
    g = _sigmoid((x * gate_w).sum(-1, keepdims=True))
    a = _A_ref(x, A_wqkv, A_w_phi, A_wo)
    b = _B_ref(x, B_w1, B_b1, B_w2)
    return g * a + (1 - g) * b
```

```asm
; @launch grid=(256,1,1) block=(256,1,1) lds=163840
.amdgcn_target "amdgcn-amd-amdhsa--gfx950"
.text
.globl gated_mix__linear_kernel_hedgehog__dense_activation_mish__prompt_kernel
.p2align 8
.type gated_mix__linear_kernel_hedgehog__dense_activation_mish__prompt_kernel,@function
gated_mix__linear_kernel_hedgehog__dense_activation_mish__prompt_kernel:
  s_load_dwordx16 s[4:19], s[0:1], 0
  s_getpc_b64 s[92:93]
  s_bfe_u32 s96, s2, 0x40003
  s_min_u32 s96, s96, (L_code_end-gated_mix__linear_kernel_hedgehog__dense_activation_mish__prompt_kernel-1)>>12
  s_lshl_b32 s96, s96, 12
  v_lshl_add_u32 v2, v0, 4, s96
  global_load_dwordx4 a[252:255], v2, s[92:93]
  s_load_dwordx8 s[20:27], s[0:1], 64
  s_cmp_ge_u32 s2, 256
  s_cbranch_scc1 L_end
  v_lshrrev_b32 v11, 6, v0
  v_and_b32 v1, 63, v0
  s_lshr_b32 s99, s2, 3
  v_readfirstlane_b32 s56, v11
  v_lshrrev_b32 v11, 3, v1
  v_lshrrev_b32 v12, 4, v1
  v_xor_b32 v12, v12, v1
  v_and_b32 v12, 7, v12
  s_and_b32 s80, s99, 7
  s_lshr_b32 s81, s99, 3
  s_and_b32 s57, s2, 1
  s_lshl3_add_u32 s57, s57, s80
  s_lshl1_add_u32 s59, s81, s80
  s_sub_u32 s83, s59, 7
  s_min_u32 s59, s59, s83
  s_movk_i32 s76, 896
  s_lshl2_add_u32 s77, s57, s56
  s_mulk_i32 s77, 28672
  s_lshl_b32 s60, s59, 7
  s_add_u32 s60, s60, s77
  s_lshl_b32 s97, s56, 12
  v_mul_u32_u24 v7, s76, v11
  s_movk_i32 s76, 6144
  v_lshl_add_u32 v5, v12, 4, v7
  v_xor_b32 v6, 64, v5
  v_add_u32 v6, s76, v6
  s_movk_i32 s76, 12288
  v_add_u32 v7, s76, v5
  v_add_u32 v8, s76, v6
  s_mov_b32 s30, 1835008
  s_mov_b32 s31, 0x20000
  s_add_u32 m0, s97, 98304
  s_waitcnt lgkmcnt(0)
  s_mov_b64 s[28:29], s[4:5]
  buffer_load_dwordx4 v5, s[28:31], s60 offen offset:0 lds
  buffer_load_dwordx4 v6, s[28:31], s60 offen offset:1024 lds
  buffer_load_dwordx4 v7, s[28:31], s60 offen offset:2048 lds
  buffer_load_dwordx4 v8, s[28:31], s60 offen offset:3072 lds
  v_lshlrev_b32 v4, 4, v1
  s_and_b32 s79, s2, 7
  s_and_b32 s58, s81, 1
  s_and_b32 s83, s2, 6
  s_add_u32 s58, s58, s83
  s_mul_i32 s76, s58, 112
  s_lshl2_add_u32 s78, s76, 64
  s_addk_i32 s76, 896
  s_and_b32 s78, s78, 0xffffff80
  s_movk_i32 s88, 2688
  s_cmp_ge_u32 s99, 16
  s_cmovk_i32 s88, 3584
  s_cselect_b32 s76, s78, s76
  s_cselect_b32 s83, 7, 6
  s_cselect_b64 s[32:33], s[14:15], s[6:7]
  v_mul_u32_u24 v11, s88, v11
  v_add_u32 v11, s76, v11
  v_lshrrev_b32 v12, 2, v1
  v_and_b32 v12, 4, v12
  v_xor_b32 v12, v12, v1
  v_and_b32 v12, 7, v12
  v_min_u32 v12, s83, v12
  v_lshl_add_u32 v9, v12, 4, v11
  s_lshl_b32 s78, s88, 3
  s_addk_i32 s78, -1024
  v_add_u32 v10, s78, v9
  s_lshl_b32 s80, s88, 4
  s_mul_i32 s78, s80, s56
  s_lshl_b32 s80, s80, 2
  s_lshl_b32 s98, s56, 11
  s_mov_b32 s82, s59
  s_mul_i32 s67, s82, s80
  s_add_u32 s67, s67, s78
  s_mov_b32 s35, 0x20000
  s_mul_i32 s34, s88, 448
  s_add_u32 m0, s98, 0
  s_nop 0
  buffer_load_dwordx4 v9, s[32:35], s67 offen offset:0 lds
  buffer_load_dwordx4 v10, s[32:35], s67 offen offset:1024 lds
  s_add_u32 s82, s82, 1
  s_cmp_eq_u32 s82, 7
  s_cselect_b32 s82, 0, s82
  s_lshl_b32 s61, s82, 7
  s_add_u32 s61, s61, s77
  s_mul_i32 s68, s82, s80
  s_add_u32 s68, s68, s78
  s_add_u32 m0, s97, 114688
  s_nop 0
  buffer_load_dwordx4 v5, s[28:31], s61 offen offset:0 lds
  buffer_load_dwordx4 v6, s[28:31], s61 offen offset:1024 lds
  buffer_load_dwordx4 v7, s[28:31], s61 offen offset:2048 lds
  buffer_load_dwordx4 v8, s[28:31], s61 offen offset:3072 lds
  s_add_u32 s82, s82, 1
  s_cmp_eq_u32 s82, 7
  s_cselect_b32 s82, 0, s82
  s_lshl_b32 s62, s82, 7
  s_add_u32 s62, s62, s77
  s_mul_i32 s69, s82, s80
  s_add_u32 s69, s69, s78
  s_mov_b32 s40, s18
  s_and_b32 s41, s19, 0xffff
  s_mov_b32 s42, 1605632
  s_mov_b32 s43, 0x20000
  s_mov_b32 s44, s10
  s_and_b32 s45, s11, 0xffff
  s_mov_b32 s46, 401408
  s_mov_b32 s47, 0x20000
  s_add_u32 s82, s82, 1
  s_cmp_eq_u32 s82, 7
  s_cselect_b32 s82, 0, s82
  s_lshl_b32 s63, s82, 7
  s_add_u32 s63, s63, s77
  s_mul_i32 s70, s82, s80
  s_add_u32 s70, s70, s78
  s_add_u32 s82, s82, 1
  s_cmp_eq_u32 s82, 7
  s_cselect_b32 s82, 0, s82
  s_lshl_b32 s64, s82, 7
  s_add_u32 s64, s64, s77
  s_mul_i32 s71, s82, s80
  s_add_u32 s71, s71, s78
  s_add_u32 s82, s82, 1
  s_cmp_eq_u32 s82, 7
  s_cselect_b32 s82, 0, s82
  s_lshl_b32 s65, s82, 7
  s_add_u32 s65, s65, s77
  s_mul_i32 s72, s82, s80
  s_add_u32 s72, s72, s78
  s_add_u32 s82, s82, 1
  s_cmp_eq_u32 s82, 7
  s_cselect_b32 s82, 0, s82
  s_lshl_b32 s66, s82, 7
  s_add_u32 s66, s66, s77
  s_mul_i32 s73, s82, s80
  s_add_u32 s73, s73, s78
  v_lshrrev_b32 v2, 5, v1
  v_and_b32 v3, 31, v1
  s_lshr_b32 s84, s56, 1
  s_and_b32 s85, s56, 1
  s_add_u32 s76, s99, 16
  s_and_b32 s76, s76, 31
  s_mul_i32 s86, s76, 37
  s_lshr_b32 s86, s86, 8
  s_mul_i32 s87, s86, 7
  s_sub_u32 s87, s76, s87
  s_add_u32 s89, s87, s86
  s_and_b32 s89, s89, 1
  s_cmp_ge_u32 s76, 28
  s_cselect_b32 s87, 7, s87
  s_min_u32 s86, s86, 3
  s_lshl2_add_u32 s86, s79, s86
  s_mov_b32 s90, 1069066811
  s_mov_b32 s91, 1069066811
  s_mov_b32 s36, s26
  s_and_b32 s37, s27, 0xffff
  s_mov_b32 s38, 16777216
  s_mov_b32 s39, 0x20000
  s_cmp_ge_u32 s99, 16
  s_cbranch_scc1 L_mlp

  s_or_b32 s76, s2, s56
  s_cmp_eq_u32 s76, 0
s_cbranch_scc1 L_make
L_make_back:
  s_mov_b32 s52, s14
  s_and_b32 s53, s15, 0xffff
  s_mov_b32 s54, 1605632
  s_mov_b32 s55, 0x20000
  s_mov_b32 s48, s8
  s_and_b32 s49, s9, 0xffff
  s_mov_b32 s50, 25088
  s_mov_b32 s51, 0x20000
  v_cmp_eq_u32 s[92:93], 1, v2
  v_mov_b32 v13, 0xff800000
  s_nop 0
  v_cndmask_b32 v11, 0, v13, s[92:93]
  v_bfe_u32 v13, v1, 4, 1
  v_lshlrev_b32 v13, 2, v13
  v_and_or_b32 v13, v1, 3, v13
  v_min_u32 v13, 6, v13
  v_bfe_u32 v14, v1, 2, 2
  v_lshl_add_u32 v14, v2, 2, v14
  v_mul_u32_u24 v14, 56, v14
  v_lshl_add_u32 v12, v13, 3, v14
  s_mul_i32 s76, s85, 1568
  s_add_u32 s76, s76, 57344
  v_add_u32 v12, s76, v12
  s_mul_i32 s76, s58, 448
  s_add_u32 s77, s76, 64
  s_and_b32 s77, s77, 0xffffff80
  s_lshl_b32 s78, s85, 6
  s_add_u32 s78, s78, s77
  s_bitcmp0_b32 s58, 0
  s_cselect_b32 s15, 384, 0
  s_add_u32 s15, s15, s76
  s_lshl_b32 s13, s78, 5
  v_lshlrev_b32 v13, 1, v3
  v_add_u32 v24, s78, v13
  v_add_u32 v25, s15, v13
  v_mov_b32 v26, 0
  v_mov_b32 v27, 0
  v_mov_b32 v14, 0x3f3504f3
  v_mov_b32 v15, 0x3f3504f3
  v_cmp_eq_u32 vcc, 0, v2
  v_mov_b32 v13, 0x3f80
  v_mov_b32 v29, 0
  v_cndmask_b32 v28, 0, v13, vcc
  v_mov_b32 v30, 0
  v_mov_b32 v31, 0
  s_add_u32 s79, s77, 128
  v_lshrrev_b32 v33, 3, v1
  v_mul_u32_u24 v33, 3584, v33
  v_add_u32 v33, s79, v33
  v_lshrrev_b32 v34, 2, v1
  v_and_b32 v34, 4, v34
  v_xor_b32 v34, v34, v1
  v_and_b32 v34, 7, v34
  v_lshl_add_u32 v13, v34, 4, v33
  v_add_u32 v32, 27648, v13
  s_lshl2_add_u32 s76, s57, s56
  s_mul_i32 s76, s76, 28672
  s_mul_i32 s76, s76, 1792
  s_mul_i32 s101, s56, 57344
  s_sub_u32 s101, s101, s76
  s_add_u32 s76, s97, 98304
  v_lshlrev_b32 v33, 7, v3
  v_add_u32 v33, s76, v33
  v_bfe_u32 v34, v3, 1, 3
  v_xor_b32 v34, v34, v2
  v_xor_b32 v35, 0, v34
  v_lshl_add_u32 v36, v35, 4, v33
  v_xor_b32 v40, 4096, v36
  v_xor_b32 v35, 2, v34
  v_lshl_add_u32 v37, v35, 4, v33
  v_xor_b32 v41, 4096, v37
  v_xor_b32 v35, 4, v34
  v_lshl_add_u32 v38, v35, 4, v33
  v_xor_b32 v42, 4096, v38
  v_xor_b32 v35, 6, v34
  v_lshl_add_u32 v39, v35, 4, v33
  v_xor_b32 v43, 4096, v39
  v_bfe_u32 v35, v1, 4, 1
  v_lshlrev_b32 v35, 2, v35
  v_and_or_b32 v35, v1, 3, v35
  s_mul_i32 s76, s85, 56
  v_cmp_eq_u32 vcc, 7, v35
  v_lshlrev_b32 v35, 3, v35
  v_add_u32 v35, s76, v35
  v_mov_b32 v44, 112
  v_cndmask_b32 v35, v35, v44, vcc
  v_and_b32 v44, 8, v1
  v_lshlrev_b32 v44, 3, v44
  v_xor_b32 v35, v35, v44
  v_bfe_u32 v44, v1, 2, 2
  v_lshl_add_u32 v44, v2, 3, v44
  v_lshl_add_u32 v33, v44, 7, v35
  v_add_u32 v34, 57344, v33
  v_bfe_u32 v44, v1, 4, 1
  v_lshlrev_b32 v44, 2, v44
  v_and_or_b32 v44, v1, 3, v44
  s_mul_i32 s76, s85, 64
  v_lshlrev_b32 v44, 3, v44
  v_add_u32 v44, s76, v44
  v_and_b32 v45, 8, v1
  v_lshlrev_b32 v45, 3, v45
  v_xor_b32 v44, v44, v45
  v_bfe_u32 v45, v1, 2, 2
  v_lshl_add_u32 v45, v2, 3, v45
  v_lshl_add_u32 v35, v45, 7, v44
  s_lshl2_add_u32 s76, s57, s56
  s_xor_b32 s77, s76, 1
  s_mul_i32 s76, s76, 147456
  s_mul_i32 s77, s77, 147456
  v_add_u32 v44, s76, v4
  v_add_u32 v45, s77, v4
  v_lshlrev_b32 v48, 3, v1
  v_cmp_gt_u32 vcc, 16, v1
  v_bfrev_b32 v49, 1
  s_nop 0
  v_cndmask_b32 v49, v49, v48, vcc
  v_mov_b32 v48, 0
  s_lshl1_add_u32 s100, s57, s84
  s_lshl3_add_u32 s100, s100, s58
  s_lshl1_add_u32 s100, s100, s85
  s_lshl_b32 s100, s100, 7
  v_lshrrev_b32 v52, 2, v1
  v_mul_u32_u24 v52, 3584, v52
  v_and_b32 v50, 3, v1
  v_lshl_add_u32 v52, v50, 4, v52
  v_add_u32 v52, s15, v52
  v_bfe_u32 v53, v1, 4, 1
  v_lshl_add_u32 v53, v53, 2, v50
  v_lshlrev_b32 v53, 3, v53
  v_bfe_u32 v50, v1, 2, 2
  v_lshl_add_u32 v50, v2, 3, v50
  v_lshl_add_u32 v53, v50, 6, v53
  v_add_u32 v53, 57344, v53
  v_and_b32 v50, 3, v1
  v_bfe_u32 v51, v1, 2, 2
  v_lshl_or_b32 v51, v50, 2, v51
  v_xor_b32 v51, v51, v2
  v_mul_u32_u24 v50, 384, v3
  v_lshl_add_u32 v50, v51, 3, v50
  s_mul_i32 s76, s56, 12288
  s_add_u32 s76, s76, 114688
  s_xor_b32 s77, s56, 1
  s_mul_i32 s77, s77, 12288
  s_add_u32 s77, s77, 114688
  s_lshl_b32 s78, s85, 7
  s_lshl_b32 s79, s85, 6
  v_add_u32 v56, s76, v50
  v_add_u32 v54, s78, v56
  v_xor_b32 v56, s79, v56
  v_add_u32 v57, s77, v50
  v_add_u32 v55, s78, v57
  v_xor_b32 v57, s79, v57
  v_bfe_u32 v50, v1, 4, 1
  v_lshlrev_b32 v50, 2, v50
  v_and_or_b32 v50, v1, 3, v50
  v_and_b32 v51, 12, v1
  v_lshl_or_b32 v51, v2, 1, v51
  v_xor_b32 v50, v50, v51
  v_bfe_u32 v51, v1, 2, 2
  v_lshl_add_u32 v51, v2, 3, v51
  v_mul_u32_u24 v51, 384, v51
  v_add_u32 v51, 114688, v51
  v_lshl_add_u32 v50, v50, 3, v51
  s_lshl_b32 s76, s84, 7
  s_lshl_b32 s77, s84, 6
  v_xor_b32 v58, s79, v50
  v_add_u32 v58, s76, v58
  v_xor_b32 v59, 8, v58
  v_xor_b32 v60, s77, v50
  v_xor_b32 v61, 8, v60
  s_min_u32 s76, s87, 6
  s_lshl_b32 s76, s76, 7
  s_cmp_eq_u32 s87, 7
  s_cselect_b32 s76, 0x40000000, s76
  v_lshrrev_b32 v218, 3, v1
  v_mul_u32_u24 v218, 896, v218
  v_add_u32 v218, s76, v218
  v_lshrrev_b32 v219, 2, v1
  v_and_b32 v219, 4, v219
  v_xor_b32 v219, v219, v1
  v_and_b32 v219, 7, v219
  v_lshl_add_u32 v62, v219, 4, v218
  v_add_u32 v63, 6144, v62
  v_add_u32 v216, 12288, v62
  v_add_u32 v217, 18432, v62
  v_bfe_u32 v218, v1, 4, 1
  v_lshlrev_b32 v218, 2, v218
  v_and_or_b32 v218, v1, 3, v218
  v_lshlrev_b32 v218, 3, v218
  v_and_b32 v219, 8, v1
  v_lshlrev_b32 v219, 3, v219
  v_xor_b32 v218, v218, v219
  v_bfe_u32 v219, v1, 2, 2
  v_lshl_add_u32 v218, v219, 7, v218
  s_mul_i32 s4, s56, 12288
  s_add_u32 s4, s4, 114688
  s_mul_i32 s5, s56, 14336
  s_mul_i32 s6, s56, 7168
  s_add_u32 s6, s6, 57344
  v_lshl_add_u32 v219, v2, 9, v218
  v_add_u32 v220, s4, v219
  v_add_u32 v222, s5, v219
  v_add_u32 v224, s6, v219
  v_add_u32 v226, s6, v218
  v_xor_b32 v221, 64, v220
  v_xor_b32 v223, 64, v222
  v_xor_b32 v225, 64, v224
  v_xor_b32 v227, 64, v226
  s_mul_i32 s7, s56, 401408
  s_mul_i32 s8, s56, 100352
  s_mul_i32 s76, s89, 229376
  s_add_u32 s18, s7, s76
  s_sub_u32 s19, s7, s76
  s_mul_i32 s76, s89, 50176
  s_sub_u32 s3, s8, s76
  s_add_u32 s8, s8, s76
  s_lshl_b32 s89, s89, 14
  s_mul_i32 s76, s86, 294912
  s_mul_i32 s77, s56, 28672
  s_add_u32 s76, s76, s77
  v_add_u32 v228, s76, v4
  v_add_u32 v229, 147456, v228
  s_lshl2_add_u32 s76, s86, s56
  s_lshl_b32 s76, s76, 2
  v_and_b32 v230, 3, v1
  v_add_u32 v230, s76, v230
  v_lshlrev_b32 v230, 7, v230
  s_lshl2_add_u32 s76, s58, s56
  s_lshl_b32 s78, s76, 15
  s_add_u32 s78, s78, 10485760
  s_lshl_b32 s10, s57, 7
  s_add_u32 s10, s10, s78
  s_lshl_b32 s14, s57, 11
  s_add_u32 s14, s14, s78
  s_lshl_b32 s76, s76, 4
  s_add_u32 s77, s76, s57
  s_lshl_b32 s11, s77, 7
  s_lshl_b32 s12, s56, 10
  s_add_u32 s13, s13, 4096
  s_lshl_b32 s15, s15, 5
  v_and_b32 v218, 15, v1
  v_add_u32 v218, s76, v218
  v_lshlrev_b32 v218, 7, v218
  v_lshrrev_b32 v50, 3, v1
  v_and_b32 v51, 7, v1
  v_lshlrev_b32 v51, 4, v51
  v_lshl_add_u32 v219, v50, 11, v51
  v_lshrrev_b32 v50, 4, v1
  v_lshl_add_u32 v231, v50, 2, v51
  v_and_b32 v50, 8, v1
  v_lshl_add_u32 v231, v50, 28, v231
  v_and_b32 v194, 15, v1
  v_lshlrev_b32 v194, 3, v194
  v_lshrrev_b32 v193, 4, v1
  s_add_u32 s76, s11, 12582912
  v_mov_b32 v192, s76
  s_add_u32 s76, s11, 12582912
  v_cmp_eq_u32 vcc, 1, v193
  v_mov_b32 v195, s76
  s_nop 0
  v_cndmask_b32 v192, v192, v195, vcc
  s_add_u32 s76, s100, 12910592
  v_cmp_eq_u32 vcc, 2, v193
  v_mov_b32 v195, s76
  s_nop 0
  v_cndmask_b32 v192, v192, v195, vcc
  s_add_u32 s76, s100, 13172736
  v_cmp_eq_u32 vcc, 3, v193
  v_mov_b32 v195, s76
  s_nop 0
  v_cndmask_b32 v192, v192, v195, vcc
  v_add_u32 v194, v192, v194
  v_mov_b32 v192, 0
  v_mov_b32 v193, 0
  s_add_u32 m0, s98, 8192
  s_nop 0
  buffer_load_dwordx4 v9, s[32:35], s68 offen offset:0 lds
  buffer_load_dwordx4 v10, s[32:35], s68 offen offset:1024 lds
  s_lshl_b32 s76, s56, 10
  s_add_u32 m0, s76, 57344
  s_mul_i32 s77, s58, 3136
  s_add_u32 s76, s76, s77
  buffer_load_dwordx4 v4, s[48:51], s76 offen lds
  global_load_ushort v24, v24, s[16:17] offset:128
  global_load_ushort v25, v25, s[16:17] offset:0
  buffer_store_dwordx2 v[192:193], v194, s[36:39], 0 offen sc1
  s_add_u32 m0, s97, 131072
  s_nop 0
  buffer_load_dwordx4 v5, s[28:31], s62 offen offset:0 lds
  buffer_load_dwordx4 v6, s[28:31], s62 offen offset:1024 lds
  buffer_load_dwordx4 v7, s[28:31], s62 offen offset:2048 lds
  buffer_load_dwordx4 v8, s[28:31], s62 offen offset:3072 lds
  s_add_u32 m0, s98, 16384
  s_nop 0
  buffer_load_dwordx4 v9, s[32:35], s69 offen offset:0 lds
  buffer_load_dwordx4 v10, s[32:35], s69 offen offset:1024 lds
  s_waitcnt vmcnt(16)
  s_barrier
  ds_read_b64_tr_b16 a[224:225], v33 offset:0
  s_add_u32 m0, s97, 147456
  ds_read_b64_tr_b16 a[226:227], v33 offset:512
  buffer_load_dwordx4 v5, s[28:31], s63 offen offset:0 lds
  ds_read_b128 a[0:3], v36 offset:0
  ds_read_b128 a[112:115], v40 offset:0
  ds_read_b64_tr_b16 a[228:229], v33 offset:2048
  ds_read_b64_tr_b16 a[230:231], v33 offset:2560
  ds_read_b128 a[4:7], v37 offset:0
  buffer_load_dwordx4 v6, s[28:31], s63 offen offset:1024 lds
  ds_read_b128 a[116:119], v41 offset:0
  ds_read_b64_tr_b16 a[232:233], v33 offset:4096
  ds_read_b64_tr_b16 a[234:235], v33 offset:4608
  ds_read_b128 a[8:11], v38 offset:0
  ds_read_b128 a[120:123], v42 offset:0
  buffer_load_dwordx4 v7, s[28:31], s63 offen offset:2048 lds
  ds_read_b64_tr_b16 a[236:237], v33 offset:6144
  ds_read_b64_tr_b16 a[238:239], v33 offset:6656
  ds_read_b128 a[12:15], v39 offset:0
  ds_read_b128 a[124:127], v43 offset:0
  buffer_load_dwordx4 v8, s[28:31], s63 offen offset:3072 lds
  s_waitcnt lgkmcnt(13)
  v_mfma_f32_32x32x16_bf16 v[64:79], a[224:227], a[0:3], 0
  s_add_u32 m0, s98, 24576
  s_nop 0
  buffer_load_dwordx4 v9, s[32:35], s70 offen offset:0 lds
  s_waitcnt lgkmcnt(12)
  v_mfma_f32_32x32x16_bf16 v[80:95], a[224:227], a[112:115], 0
  s_waitcnt lgkmcnt(9)
  v_mfma_f32_32x32x16_bf16 v[64:79], a[228:231], a[4:7], v[64:79]
  buffer_load_dwordx4 v10, s[32:35], s70 offen offset:1024 lds
  s_waitcnt lgkmcnt(8)
  v_mfma_f32_32x32x16_bf16 v[80:95], a[228:231], a[116:119], v[80:95]
  s_waitcnt vmcnt(16)
  s_waitcnt lgkmcnt(0)
  s_barrier
  v_mfma_f32_32x32x16_bf16 v[64:79], a[232:235], a[8:11], v[64:79]
  ds_read_b64_tr_b16 a[240:241], v33 offset:8192
  s_add_u32 m0, s97, 98304
  ds_read_b64_tr_b16 a[242:243], v33 offset:8704
  ds_read_b128 a[16:19], v36 offset:16384
  buffer_load_dwordx4 v5, s[28:31], s64 offen offset:0 lds
  ds_read_b128 a[128:131], v40 offset:16384
  ds_read_b64_tr_b16 a[244:245], v33 offset:10240
  ds_read_b64_tr_b16 a[246:247], v33 offset:10752
  ds_read_b128 a[20:23], v37 offset:16384
  ds_read_b128 a[132:135], v41 offset:16384
  v_mfma_f32_32x32x16_bf16 v[80:95], a[232:235], a[120:123], v[80:95]
  ds_read_b64_tr_b16 a[248:249], v33 offset:12288
  ds_read_b64_tr_b16 a[250:251], v33 offset:12800
  ds_read_b128 a[24:27], v38 offset:16384
  ds_read_b128 a[136:139], v42 offset:16384
  ds_read_b64_tr_b16 a[252:253], v33 offset:14336
  ds_read_b64_tr_b16 a[254:255], v33 offset:14848
  buffer_load_dwordx4 v6, s[28:31], s64 offen offset:1024 lds
  ds_read_b128 a[28:31], v39 offset:16384
  ds_read_b128 a[140:143], v43 offset:16384
  v_mfma_f32_32x32x16_bf16 v[64:79], a[236:239], a[12:15], v[64:79]
  buffer_load_dwordx4 v7, s[28:31], s64 offen offset:2048 lds
  v_mfma_f32_32x32x16_bf16 v[80:95], a[236:239], a[124:127], v[80:95]
  s_waitcnt lgkmcnt(13)
  v_mfma_f32_32x32x16_bf16 v[64:79], a[240:243], a[16:19], v[64:79]
  buffer_load_dwordx4 v8, s[28:31], s64 offen offset:3072 lds
  s_waitcnt lgkmcnt(12)
  v_mfma_f32_32x32x16_bf16 v[80:95], a[240:243], a[128:131], v[80:95]
  s_add_u32 m0, s98, 32768
  s_nop 0
  buffer_load_dwordx4 v9, s[32:35], s71 offen offset:0 lds
  s_waitcnt lgkmcnt(9)
  v_mfma_f32_32x32x16_bf16 v[64:79], a[244:247], a[20:23], v[64:79]
  buffer_load_dwordx4 v10, s[32:35], s71 offen offset:1024 lds
  s_waitcnt lgkmcnt(8)
  v_mfma_f32_32x32x16_bf16 v[80:95], a[244:247], a[132:135], v[80:95]
  s_waitcnt vmcnt(12)
  s_waitcnt lgkmcnt(0)
  s_barrier
  v_mfma_f32_32x32x16_bf16 v[64:79], a[248:251], a[24:27], v[64:79]
  ds_read_b64_tr_b16 a[224:225], v33 offset:16384
  s_add_u32 m0, s97, 114688
  ds_read_b64_tr_b16 a[226:227], v33 offset:16896
  ds_read_b128 a[32:35], v36 offset:32768
  buffer_load_dwordx4 v5, s[28:31], s65 offen offset:0 lds
  ds_read_b128 a[144:147], v40 offset:32768
  ds_read_b64_tr_b16 a[228:229], v33 offset:18432
  ds_read_b64_tr_b16 a[230:231], v33 offset:18944
  ds_read_b128 a[36:39], v37 offset:32768
  ds_read_b128 a[148:151], v41 offset:32768
  v_mfma_f32_32x32x16_bf16 v[80:95], a[248:251], a[136:139], v[80:95]
  ds_read_b64_tr_b16 a[232:233], v33 offset:20480
  ds_read_b64_tr_b16 a[234:235], v33 offset:20992
  ds_read_b128 a[40:43], v38 offset:32768
  ds_read_b128 a[152:155], v42 offset:32768
  ds_read_b64_tr_b16 a[236:237], v33 offset:22528
  ds_read_b64_tr_b16 a[238:239], v33 offset:23040
  buffer_load_dwordx4 v6, s[28:31], s65 offen offset:1024 lds
  ds_read_b128 a[44:47], v39 offset:32768
  ds_read_b128 a[156:159], v43 offset:32768
  v_mfma_f32_32x32x16_bf16 v[64:79], a[252:255], a[28:31], v[64:79]
  buffer_load_dwordx4 v7, s[28:31], s65 offen offset:2048 lds
  v_mfma_f32_32x32x16_bf16 v[80:95], a[252:255], a[140:143], v[80:95]
  s_waitcnt lgkmcnt(13)
  v_mfma_f32_32x32x16_bf16 v[64:79], a[224:227], a[32:35], v[64:79]
  buffer_load_dwordx4 v8, s[28:31], s65 offen offset:3072 lds
  s_waitcnt lgkmcnt(12)
  v_mfma_f32_32x32x16_bf16 v[80:95], a[224:227], a[144:147], v[80:95]
  s_add_u32 m0, s98, 40960
  s_nop 0
  buffer_load_dwordx4 v9, s[32:35], s72 offen offset:0 lds
  s_waitcnt lgkmcnt(9)
  v_mfma_f32_32x32x16_bf16 v[64:79], a[228:231], a[36:39], v[64:79]
  buffer_load_dwordx4 v10, s[32:35], s72 offen offset:1024 lds
  s_waitcnt lgkmcnt(8)
  v_mfma_f32_32x32x16_bf16 v[80:95], a[228:231], a[148:151], v[80:95]
  s_waitcnt vmcnt(12)
  s_waitcnt lgkmcnt(0)
  s_barrier
  v_mfma_f32_32x32x16_bf16 v[64:79], a[232:235], a[40:43], v[64:79]
  ds_read_b64_tr_b16 v[16:17], v12 offset:0
  s_add_u32 m0, s97, 131072
  ds_read_b64_tr_b16 v[18:19], v12 offset:448
  ds_read_b64_tr_b16 v[20:21], v12 offset:896
  ds_read_b64_tr_b16 v[22:23], v12 offset:1344
  buffer_load_dwordx4 v5, s[28:31], s66 offen offset:0 lds
  ds_read_b64_tr_b16 a[240:241], v33 offset:24576
  ds_read_b64_tr_b16 a[242:243], v33 offset:25088
  ds_read_b128 a[48:51], v36 offset:49152
  ds_read_b128 a[160:163], v40 offset:49152
  ds_read_b64_tr_b16 a[244:245], v33 offset:26624
  ds_read_b64_tr_b16 a[246:247], v33 offset:27136
  v_mfma_f32_32x32x16_bf16 v[80:95], a[232:235], a[152:155], v[80:95]
  ds_read_b128 a[52:55], v37 offset:49152
  ds_read_b128 a[164:167], v41 offset:49152
  ds_read_b64_tr_b16 a[248:249], v33 offset:28672
  ds_read_b64_tr_b16 a[250:251], v33 offset:29184
  ds_read_b128 a[56:59], v38 offset:49152
  ds_read_b128 a[168:171], v42 offset:49152
  ds_read_b64_tr_b16 a[252:253], v33 offset:30720
  buffer_load_dwordx4 v6, s[28:31], s66 offen offset:1024 lds
  ds_read_b64_tr_b16 a[254:255], v33 offset:31232
  ds_read_b128 a[60:63], v39 offset:49152
  ds_read_b128 a[172:175], v43 offset:49152
  v_mfma_f32_32x32x16_bf16 v[64:79], a[236:239], a[44:47], v[64:79]
  buffer_load_dwordx4 v7, s[28:31], s66 offen offset:2048 lds
  v_mfma_f32_32x32x16_bf16 v[80:95], a[236:239], a[156:159], v[80:95]
  s_waitcnt lgkmcnt(13)
  v_mfma_f32_32x32x16_bf16 v[64:79], a[240:243], a[48:51], v[64:79]
  buffer_load_dwordx4 v8, s[28:31], s66 offen offset:3072 lds
  s_waitcnt lgkmcnt(12)
  v_mfma_f32_32x32x16_bf16 v[80:95], a[240:243], a[160:163], v[80:95]
  s_add_u32 m0, s98, 49152
  s_nop 0
  buffer_load_dwordx4 v9, s[32:35], s73 offen offset:0 lds
  s_waitcnt lgkmcnt(9)
  v_mfma_f32_32x32x16_bf16 v[64:79], a[244:247], a[52:55], v[64:79]
  buffer_load_dwordx4 v10, s[32:35], s73 offen offset:1024 lds
  s_waitcnt lgkmcnt(8)
  v_mfma_f32_32x32x16_bf16 v[80:95], a[244:247], a[164:167], v[80:95]
  s_waitcnt vmcnt(12)
  s_waitcnt lgkmcnt(0)
  s_barrier
  v_mfma_f32_32x32x16_bf16 v[64:79], a[248:251], a[56:59], v[64:79]
  v_cndmask_b32 v22, v22, 0, s[92:93]
  v_add_u32 v9, 896, v9
  v_cndmask_b32 v23, v23, 0, s[92:93]
  ds_read_b64_tr_b16 a[224:225], v33 offset:32768
  ds_read_b64_tr_b16 a[226:227], v33 offset:33280
  ds_read_b128 a[64:67], v36 offset:0
  v_add_u32 v10, 896, v10
  ds_read_b128 a[176:179], v40 offset:0
  ds_read_b64_tr_b16 a[228:229], v33 offset:34816
  ds_read_b64_tr_b16 a[230:231], v33 offset:35328
  s_add_u32 m0, s98, 57344
  ds_read_b128 a[68:71], v37 offset:0
  v_mfma_f32_32x32x16_bf16 v[80:95], a[248:251], a[168:171], v[80:95]
  ds_read_b128 a[180:183], v41 offset:0
  ds_read_b64_tr_b16 a[232:233], v33 offset:36864
  buffer_load_dwordx4 v9, s[32:35], s67 offen offset:0 lds
  ds_read_b64_tr_b16 a[234:235], v33 offset:37376
  ds_read_b128 a[72:75], v38 offset:0
  ds_read_b128 a[184:187], v42 offset:0
  ds_read_b64_tr_b16 a[236:237], v33 offset:38912
  ds_read_b64_tr_b16 a[238:239], v33 offset:39424
  ds_read_b128 a[76:79], v39 offset:0
  ds_read_b128 a[188:191], v43 offset:0
  v_mfma_f32_32x32x16_bf16 v[64:79], a[252:255], a[60:63], v[64:79]
  buffer_load_dwordx4 v10, s[32:35], s67 offen offset:1024 lds
  v_mfma_f32_32x32x16_bf16 v[80:95], a[252:255], a[172:175], v[80:95]
  s_waitcnt lgkmcnt(13)
  v_mfma_f32_32x32x16_bf16 v[64:79], a[224:227], a[64:67], v[64:79]
  s_add_u32 m0, s98, 65536
  s_nop 0
  buffer_load_dwordx4 v9, s[32:35], s68 offen offset:0 lds
  s_waitcnt lgkmcnt(12)
  v_mfma_f32_32x32x16_bf16 v[80:95], a[224:227], a[176:179], v[80:95]
  s_waitcnt lgkmcnt(9)
  v_mfma_f32_32x32x16_bf16 v[64:79], a[228:231], a[68:71], v[64:79]
  buffer_load_dwordx4 v10, s[32:35], s68 offen offset:1024 lds
  s_waitcnt lgkmcnt(8)
  v_mfma_f32_32x32x16_bf16 v[80:95], a[228:231], a[180:183], v[80:95]
  s_waitcnt vmcnt(10)
  s_waitcnt lgkmcnt(0)
  s_barrier
  v_mfma_f32_32x32x16_bf16 v[64:79], a[232:235], a[72:75], v[64:79]
  ds_read_b64_tr_b16 a[240:241], v33 offset:40960
  s_add_u32 m0, s98, 73728
  ds_read_b64_tr_b16 a[242:243], v33 offset:41472
  ds_read_b128 a[80:83], v36 offset:16384
  ds_read_b128 a[192:195], v40 offset:16384
  buffer_load_dwordx4 v9, s[32:35], s69 offen offset:0 lds
  ds_read_b64_tr_b16 a[244:245], v33 offset:43008
  ds_read_b64_tr_b16 a[246:247], v33 offset:43520
  ds_read_b128 a[84:87], v37 offset:16384
  ds_read_b128 a[196:199], v41 offset:16384
  v_mfma_f32_32x32x16_bf16 v[80:95], a[232:235], a[184:187], v[80:95]
  ds_read_b64_tr_b16 a[248:249], v33 offset:45056
  ds_read_b64_tr_b16 a[250:251], v33 offset:45568
  ds_read_b128 a[88:91], v38 offset:16384
  ds_read_b128 a[200:203], v42 offset:16384
  ds_read_b64_tr_b16 a[252:253], v33 offset:47104
  ds_read_b64_tr_b16 a[254:255], v33 offset:47616
  ds_read_b128 a[92:95], v39 offset:16384
  ds_read_b128 a[204:207], v43 offset:16384
  v_mfma_f32_32x32x16_bf16 v[64:79], a[236:239], a[76:79], v[64:79]
  buffer_load_dwordx4 v10, s[32:35], s69 offen offset:1024 lds
  v_mfma_f32_32x32x16_bf16 v[80:95], a[236:239], a[188:191], v[80:95]
  s_waitcnt lgkmcnt(13)
  v_mfma_f32_32x32x16_bf16 v[64:79], a[240:243], a[80:83], v[64:79]
  s_add_u32 m0, s98, 81920
  s_nop 0
  buffer_load_dwordx4 v9, s[32:35], s70 offen offset:0 lds
  s_waitcnt lgkmcnt(12)
  v_mfma_f32_32x32x16_bf16 v[80:95], a[240:243], a[192:195], v[80:95]
  s_waitcnt lgkmcnt(9)
  v_mfma_f32_32x32x16_bf16 v[64:79], a[244:247], a[84:87], v[64:79]
  buffer_load_dwordx4 v10, s[32:35], s70 offen offset:1024 lds
  s_waitcnt lgkmcnt(8)
  v_mfma_f32_32x32x16_bf16 v[80:95], a[244:247], a[196:199], v[80:95]
  s_waitcnt vmcnt(8)
  s_waitcnt lgkmcnt(0)
  s_barrier
  v_mfma_f32_32x32x16_bf16 v[64:79], a[248:251], a[88:91], v[64:79]
  ds_read_b64_tr_b16 a[224:225], v33 offset:49152
  s_add_u32 m0, s98, 90112
  ds_read_b64_tr_b16 a[226:227], v33 offset:49664
  ds_read_b128 a[96:99], v36 offset:32768
  ds_read_b128 a[208:211], v40 offset:32768
  ds_read_b64_tr_b16 a[228:229], v33 offset:51200
  ds_read_b64_tr_b16 a[230:231], v33 offset:51712
  ds_read_b128 a[100:103], v37 offset:32768
  ds_read_b128 a[212:215], v41 offset:32768
  buffer_load_dwordx4 v9, s[32:35], s71 offen offset:0 lds
  v_mfma_f32_32x32x16_bf16 v[80:95], a[248:251], a[200:203], v[80:95]
  ds_read_b64_tr_b16 a[232:233], v33 offset:53248
  ds_read_b64_tr_b16 a[234:235], v33 offset:53760
  ds_read_b128 a[104:107], v38 offset:32768
  ds_read_b128 a[216:219], v42 offset:32768
  ds_read_b64_tr_b16 a[236:237], v33 offset:55296
  ds_read_b64_tr_b16 a[238:239], v33 offset:55808
  ds_read_b128 a[108:111], v39 offset:32768
  ds_read_b128 a[220:223], v43 offset:32768
  v_mfma_f32_32x32x16_bf16 v[64:79], a[252:255], a[92:95], v[64:79]
  v_mfma_f32_32x32x16_bf16 v[80:95], a[252:255], a[204:207], v[80:95]
  s_waitcnt lgkmcnt(13)
  v_mfma_f32_32x32x16_bf16 v[64:79], a[224:227], a[96:99], v[64:79]
  buffer_load_dwordx4 v10, s[32:35], s71 offen offset:1024 lds
  s_waitcnt lgkmcnt(12)
  v_mfma_f32_32x32x16_bf16 v[80:95], a[224:227], a[208:211], v[80:95]
  s_waitcnt lgkmcnt(9)
  v_mfma_f32_32x32x16_bf16 v[64:79], a[228:231], a[100:103], v[64:79]
  s_waitcnt lgkmcnt(8)
  v_mfma_f32_32x32x16_bf16 v[80:95], a[228:231], a[212:215], v[80:95]
  s_waitcnt lgkmcnt(5)
  v_mfma_f32_32x32x16_bf16 v[64:79], a[232:235], a[104:107], v[64:79]
  s_mul_i32 s60, s60, 1792
  s_add_u32 s60, s60, s101
  s_mul_i32 s61, s61, 1792
  s_add_u32 s61, s61, s101
  s_waitcnt lgkmcnt(4)
  v_mfma_f32_32x32x16_bf16 v[80:95], a[232:235], a[216:219], v[80:95]
  s_mul_i32 s62, s62, 1792
  s_add_u32 s62, s62, s101
  s_mul_i32 s63, s63, 1792
  s_add_u32 s63, s63, s101
  s_waitcnt lgkmcnt(1)
  v_mfma_f32_32x32x16_bf16 v[64:79], a[236:239], a[108:111], v[64:79]
  s_mul_i32 s64, s64, 1792
  s_add_u32 s64, s64, s101
  s_mul_i32 s65, s65, 1792
  s_add_u32 s65, s65, s101
  s_waitcnt lgkmcnt(0)
  v_mfma_f32_32x32x16_bf16 v[80:95], a[236:239], a[220:223], v[80:95]
  s_mul_i32 s66, s66, 1792
  s_add_u32 s66, s66, s101
  s_nop 3
  v_cvt_pk_bf16_f32 v176, v64, v65
  v_cvt_pk_bf16_f32 v177, v66, v67
  v_cvt_pk_bf16_f32 v178, v68, v69
  v_cvt_pk_bf16_f32 v179, v70, v71
  v_cvt_pk_bf16_f32 v180, v72, v73
  v_cvt_pk_bf16_f32 v181, v74, v75
  v_cvt_pk_bf16_f32 v182, v76, v77
  v_cvt_pk_bf16_f32 v183, v78, v79
  v_mfma_f32_32x32x16_bf16 v[128:143], v[16:19], v[176:179], 0
  s_nop 0
  v_mfma_f32_32x32x16_bf16 v[128:143], v[20:23], v[180:183], v[128:143]
  v_cvt_pk_bf16_f32 v184, v80, v81
  v_cvt_pk_bf16_f32 v185, v82, v83
  v_cvt_pk_bf16_f32 v186, v84, v85
  v_cvt_pk_bf16_f32 v187, v86, v87
  v_cvt_pk_bf16_f32 v188, v88, v89
  v_cvt_pk_bf16_f32 v189, v90, v91
  v_cvt_pk_bf16_f32 v190, v92, v93
  v_cvt_pk_bf16_f32 v191, v94, v95
  v_mfma_f32_32x32x16_bf16 v[144:159], v[16:19], v[184:187], 0
  s_nop 0
  v_mfma_f32_32x32x16_bf16 v[144:159], v[20:23], v[188:191], v[144:159]
  s_nop 0
  v_max3_f32 v208, v128, v129, v130
  s_add_u32 m0, s98, 98304
  v_min3_f32 v209, v128, v129, v130
  v_max3_f32 v208, v208, v131, v132
  v_min3_f32 v209, v209, v131, v132
  v_max3_f32 v208, v208, v133, v134
  v_min3_f32 v209, v209, v133, v134
  buffer_load_dwordx4 v9, s[32:35], s72 offen offset:0 lds
  v_max3_f32 v208, v208, v135, v136
  v_min3_f32 v209, v209, v135, v136
  v_max3_f32 v208, v208, v137, v138
  v_min3_f32 v209, v209, v137, v138
  v_max3_f32 v208, v208, v139, v140
  v_min3_f32 v209, v209, v139, v140
  v_max3_f32 v208, v208, v141, v142
  v_min3_f32 v209, v209, v141, v142
  v_max_f32 v208, v208, v143
  v_max_f32 v209, -v209, -v143
  s_nop 1
  v_permlane32_swap_b32 v208, v209
  v_max_f32 v208, v208, v209
  v_mul_f32 v210, -v208, s90
  v_mul_f32 v212, -v208, s90
  s_nop 1
  v_permlane32_swap_b32 v210, v212
  v_add_f32 v211, v210, v11
  v_add_f32 v213, v212, v11
  v_pk_fma_f32 v[192:193], v[128:129], s[90:91], v[210:211] op_sel:[0,0,0] op_sel_hi:[1,1,0]
  v_pk_fma_f32 v[128:129], v[128:129], s[90:91], v[212:213] op_sel:[0,0,0] op_sel_hi:[1,1,0] neg_lo:[1,0,0] neg_hi:[1,0,0]
  v_pk_fma_f32 v[194:195], v[130:131], s[90:91], v[210:211] op_sel:[0,0,0] op_sel_hi:[1,1,0]
  v_pk_fma_f32 v[130:131], v[130:131], s[90:91], v[212:213] op_sel:[0,0,0] op_sel_hi:[1,1,0] neg_lo:[1,0,0] neg_hi:[1,0,0]
  v_exp_f32 v192, v192
  buffer_load_dwordx4 v10, s[32:35], s72 offen offset:1024 lds
  v_exp_f32 v128, v128
  v_exp_f32 v193, v193
  v_exp_f32 v129, v129
  v_exp_f32 v194, v194
  v_exp_f32 v130, v130
  v_exp_f32 v195, v195
  v_exp_f32 v131, v131
  v_pk_fma_f32 v[196:197], v[132:133], s[90:91], v[210:211] op_sel:[0,0,0] op_sel_hi:[1,1,0]
  v_pk_fma_f32 v[132:133], v[132:133], s[90:91], v[212:213] op_sel:[0,0,0] op_sel_hi:[1,1,0] neg_lo:[1,0,0] neg_hi:[1,0,0]
  v_pk_fma_f32 v[198:199], v[134:135], s[90:91], v[210:211] op_sel:[0,0,0] op_sel_hi:[1,1,0]
  v_pk_fma_f32 v[134:135], v[134:135], s[90:91], v[212:213] op_sel:[0,0,0] op_sel_hi:[1,1,0] neg_lo:[1,0,0] neg_hi:[1,0,0]
  v_exp_f32 v196, v196
  v_exp_f32 v132, v132
  s_add_u32 m0, s98, 106496
  v_exp_f32 v197, v197
  v_exp_f32 v133, v133
  v_exp_f32 v198, v198
  buffer_load_dwordx4 v9, s[32:35], s73 offen offset:0 lds
  v_exp_f32 v134, v134
  v_exp_f32 v199, v199
  v_exp_f32 v135, v135
  v_pk_fma_f32 v[200:201], v[136:137], s[90:91], v[210:211] op_sel:[0,0,0] op_sel_hi:[1,1,0]
  v_pk_fma_f32 v[136:137], v[136:137], s[90:91], v[212:213] op_sel:[0,0,0] op_sel_hi:[1,1,0] neg_lo:[1,0,0] neg_hi:[1,0,0]
  v_pk_fma_f32 v[202:203], v[138:139], s[90:91], v[210:211] op_sel:[0,0,0] op_sel_hi:[1,1,0]
  v_pk_fma_f32 v[138:139], v[138:139], s[90:91], v[212:213] op_sel:[0,0,0] op_sel_hi:[1,1,0] neg_lo:[1,0,0] neg_hi:[1,0,0]
  v_exp_f32 v200, v200
  v_exp_f32 v136, v136
  v_exp_f32 v201, v201
  v_exp_f32 v137, v137
  v_exp_f32 v202, v202
  v_exp_f32 v138, v138
  v_exp_f32 v203, v203
  buffer_load_dwordx4 v10, s[32:35], s73 offen offset:1024 lds
  v_exp_f32 v139, v139
  v_pk_fma_f32 v[204:205], v[140:141], s[90:91], v[210:211] op_sel:[0,0,1] op_sel_hi:[1,1,1]
  v_pk_fma_f32 v[140:141], v[140:141], s[90:91], v[212:213] op_sel:[0,0,1] op_sel_hi:[1,1,1] neg_lo:[1,0,0] neg_hi:[1,0,0]
  v_pk_fma_f32 v[206:207], v[142:143], s[90:91], v[210:211] op_sel:[0,0,1] op_sel_hi:[1,1,1]
  v_pk_fma_f32 v[142:143], v[142:143], s[90:91], v[212:213] op_sel:[0,0,1] op_sel_hi:[1,1,1] neg_lo:[1,0,0] neg_hi:[1,0,0]
  v_exp_f32 v204, v204
  v_exp_f32 v140, v140
  v_exp_f32 v205, v205
  v_exp_f32 v141, v141
  v_exp_f32 v206, v206
  v_exp_f32 v142, v142
  v_exp_f32 v207, v207
  v_exp_f32 v143, v143
  global_load_dwordx2 v[46:47], v48, s[24:25] sc1
  v_pk_add_f32 v[210:211], v[192:193], v[194:195]
  v_pk_add_f32 v[212:213], v[128:129], v[130:131]
  v_pk_add_f32 v[210:211], v[210:211], v[196:197]
  v_pk_add_f32 v[212:213], v[212:213], v[132:133]
  v_pk_add_f32 v[210:211], v[210:211], v[198:199]
  v_pk_add_f32 v[212:213], v[212:213], v[134:135]
  v_pk_add_f32 v[210:211], v[210:211], v[200:201]
  v_pk_add_f32 v[212:213], v[212:213], v[136:137]
  v_pk_add_f32 v[210:211], v[210:211], v[202:203]
  v_pk_add_f32 v[212:213], v[212:213], v[138:139]
  v_pk_add_f32 v[210:211], v[210:211], v[204:205]
  v_pk_add_f32 v[212:213], v[212:213], v[140:141]
  v_pk_add_f32 v[210:211], v[210:211], v[206:207]
  v_pk_add_f32 v[212:213], v[212:213], v[142:143]
  v_add_f32 v208, v210, v211
  v_add_f32 v209, v212, v213
  s_nop 1
  v_permlane32_swap_b32 v208, v209
  v_add_f32 v208, v208, v209
  v_rcp_f32 v208, v208
  s_nop 0
  v_mov_b32 v209, v208
  s_nop 1
  v_permlane32_swap_b32 v208, v209
  v_pk_mul_f32 v[192:193], v[192:193], v[208:209] op_sel:[0,0] op_sel_hi:[1,0]
  v_pk_mul_f32 v[194:195], v[194:195], v[208:209] op_sel:[0,0] op_sel_hi:[1,0]
  v_pk_mul_f32 v[196:197], v[196:197], v[208:209] op_sel:[0,0] op_sel_hi:[1,0]
  v_pk_mul_f32 v[198:199], v[198:199], v[208:209] op_sel:[0,0] op_sel_hi:[1,0]
  v_pk_mul_f32 v[200:201], v[200:201], v[208:209] op_sel:[0,0] op_sel_hi:[1,0]
  v_pk_mul_f32 v[202:203], v[202:203], v[208:209] op_sel:[0,0] op_sel_hi:[1,0]
  v_pk_mul_f32 v[204:205], v[204:205], v[208:209] op_sel:[0,0] op_sel_hi:[1,0]
  v_pk_mul_f32 v[206:207], v[206:207], v[208:209] op_sel:[0,0] op_sel_hi:[1,0]
  v_cvt_pk_bf16_f32 v160, v192, v193
  v_cvt_pk_bf16_f32 v161, v194, v195
  v_cvt_pk_bf16_f32 v162, v196, v197
  v_cvt_pk_bf16_f32 v163, v198, v199
  v_cvt_pk_bf16_f32 v164, v200, v201
  v_cvt_pk_bf16_f32 v165, v202, v203
  v_cvt_pk_bf16_f32 v166, v204, v205
  v_cvt_pk_bf16_f32 v167, v206, v207
  v_pk_mul_f32 v[128:129], v[128:129], v[208:209] op_sel:[0,1] op_sel_hi:[1,1]
  v_pk_mul_f32 v[130:131], v[130:131], v[208:209] op_sel:[0,1] op_sel_hi:[1,1]
  v_pk_mul_f32 v[132:133], v[132:133], v[208:209] op_sel:[0,1] op_sel_hi:[1,1]
  v_pk_mul_f32 v[134:135], v[134:135], v[208:209] op_sel:[0,1] op_sel_hi:[1,1]
  v_pk_mul_f32 v[136:137], v[136:137], v[208:209] op_sel:[0,1] op_sel_hi:[1,1]
  v_pk_mul_f32 v[138:139], v[138:139], v[208:209] op_sel:[0,1] op_sel_hi:[1,1]
  v_pk_mul_f32 v[140:141], v[140:141], v[208:209] op_sel:[0,1] op_sel_hi:[1,1]
  v_pk_mul_f32 v[142:143], v[142:143], v[208:209] op_sel:[0,1] op_sel_hi:[1,1]
  v_cvt_pk_bf16_f32 v168, v128, v129
  v_cvt_pk_bf16_f32 v169, v130, v131
  v_cvt_pk_bf16_f32 v170, v132, v133
  v_cvt_pk_bf16_f32 v171, v134, v135
  v_cvt_pk_bf16_f32 v172, v136, v137
  v_cvt_pk_bf16_f32 v173, v138, v139
  v_cvt_pk_bf16_f32 v174, v140, v141
  v_cvt_pk_bf16_f32 v175, v142, v143
  v_mfma_f32_32x32x16_bf16 v[64:79], v[24:27], v[28:31], 0
  v_mfma_f32_32x32x16_bf16 v[80:95], v[24:27], v[28:31], 0
  v_max3_f32 v208, v144, v145, v146
  v_min3_f32 v209, v144, v145, v146
  v_max3_f32 v208, v208, v147, v148
  v_min3_f32 v209, v209, v147, v148
  v_max3_f32 v208, v208, v149, v150
  v_min3_f32 v209, v209, v149, v150
  v_max3_f32 v208, v208, v151, v152
  v_min3_f32 v209, v209, v151, v152
  v_max3_f32 v208, v208, v153, v154
  v_min3_f32 v209, v209, v153, v154
  v_max3_f32 v208, v208, v155, v156
  v_min3_f32 v209, v209, v155, v156
  v_max3_f32 v208, v208, v157, v158
  v_min3_f32 v209, v209, v157, v158
  v_max_f32 v208, v208, v159
  v_max_f32 v209, -v209, -v159
  s_nop 1
  v_permlane32_swap_b32 v208, v209
  v_max_f32 v208, v208, v209
  v_mul_f32 v210, -v208, s90
  v_mul_f32 v212, -v208, s90
  s_nop 1
  v_permlane32_swap_b32 v210, v212
  v_add_f32 v211, v210, v11
  v_add_f32 v213, v212, v11
  v_pk_fma_f32 v[192:193], v[144:145], s[90:91], v[210:211] op_sel:[0,0,0] op_sel_hi:[1,1,0]
  v_pk_fma_f32 v[144:145], v[144:145], s[90:91], v[212:213] op_sel:[0,0,0] op_sel_hi:[1,1,0] neg_lo:[1,0,0] neg_hi:[1,0,0]
  v_pk_fma_f32 v[194:195], v[146:147], s[90:91], v[210:211] op_sel:[0,0,0] op_sel_hi:[1,1,0]
  v_pk_fma_f32 v[146:147], v[146:147], s[90:91], v[212:213] op_sel:[0,0,0] op_sel_hi:[1,1,0] neg_lo:[1,0,0] neg_hi:[1,0,0]
  v_exp_f32 v192, v192
  v_exp_f32 v144, v144
  v_exp_f32 v193, v193
  v_exp_f32 v145, v145
  v_exp_f32 v194, v194
  v_exp_f32 v146, v146
  v_exp_f32 v195, v195
  v_exp_f32 v147, v147
  v_pk_fma_f32 v[196:197], v[148:149], s[90:91], v[210:211] op_sel:[0,0,0] op_sel_hi:[1,1,0]
  v_pk_fma_f32 v[148:149], v[148:149], s[90:91], v[212:213] op_sel:[0,0,0] op_sel_hi:[1,1,0] neg_lo:[1,0,0] neg_hi:[1,0,0]
  v_pk_fma_f32 v[198:199], v[150:151], s[90:91], v[210:211] op_sel:[0,0,0] op_sel_hi:[1,1,0]
  v_pk_fma_f32 v[150:151], v[150:151], s[90:91], v[212:213] op_sel:[0,0,0] op_sel_hi:[1,1,0] neg_lo:[1,0,0] neg_hi:[1,0,0]
  s_add_u32 m0, s98, 0
  v_exp_f32 v196, v196
  v_exp_f32 v148, v148
  buffer_load_dwordx4 v13, s[52:55], s60 offen offset:0 lds
  v_exp_f32 v197, v197
  v_exp_f32 v149, v149
  v_exp_f32 v198, v198
  v_exp_f32 v150, v150
  v_exp_f32 v199, v199
  v_exp_f32 v151, v151
  v_pk_fma_f32 v[200:201], v[152:153], s[90:91], v[210:211] op_sel:[0,0,0] op_sel_hi:[1,1,0]
  v_pk_fma_f32 v[152:153], v[152:153], s[90:91], v[212:213] op_sel:[0,0,0] op_sel_hi:[1,1,0] neg_lo:[1,0,0] neg_hi:[1,0,0]
  v_pk_fma_f32 v[202:203], v[154:155], s[90:91], v[210:211] op_sel:[0,0,0] op_sel_hi:[1,1,0]
  buffer_load_dwordx4 v32, s[52:55], s60 offen offset:1024 lds
  v_pk_fma_f32 v[154:155], v[154:155], s[90:91], v[212:213] op_sel:[0,0,0] op_sel_hi:[1,1,0] neg_lo:[1,0,0] neg_hi:[1,0,0]
  v_exp_f32 v200, v200
  v_exp_f32 v152, v152
  v_exp_f32 v201, v201
  v_exp_f32 v153, v153
  v_exp_f32 v202, v202
  v_exp_f32 v154, v154
  v_exp_f32 v203, v203
  v_exp_f32 v155, v155
  s_add_u32 m0, s98, 8192
  v_pk_fma_f32 v[204:205], v[156:157], s[90:91], v[210:211] op_sel:[0,0,1] op_sel_hi:[1,1,1]
  v_pk_fma_f32 v[156:157], v[156:157], s[90:91], v[212:213] op_sel:[0,0,1] op_sel_hi:[1,1,1] neg_lo:[1,0,0] neg_hi:[1,0,0]
  buffer_load_dwordx4 v13, s[52:55], s61 offen offset:0 lds
  v_pk_fma_f32 v[206:207], v[158:159], s[90:91], v[210:211] op_sel:[0,0,1] op_sel_hi:[1,1,1]
  v_pk_fma_f32 v[158:159], v[158:159], s[90:91], v[212:213] op_sel:[0,0,1] op_sel_hi:[1,1,1] neg_lo:[1,0,0] neg_hi:[1,0,0]
  v_exp_f32 v204, v204
  v_exp_f32 v156, v156
  v_exp_f32 v205, v205
  v_exp_f32 v157, v157
  v_exp_f32 v206, v206
  v_exp_f32 v158, v158
  v_exp_f32 v207, v207
  buffer_load_dwordx4 v32, s[52:55], s61 offen offset:1024 lds
  v_exp_f32 v159, v159
  v_pk_add_f32 v[210:211], v[192:193], v[194:195]
  v_pk_add_f32 v[212:213], v[144:145], v[146:147]
  v_pk_add_f32 v[210:211], v[210:211], v[196:197]
  v_pk_add_f32 v[212:213], v[212:213], v[148:149]
  v_pk_add_f32 v[210:211], v[210:211], v[198:199]
  v_pk_add_f32 v[212:213], v[212:213], v[150:151]
  v_pk_add_f32 v[210:211], v[210:211], v[200:201]
  v_pk_add_f32 v[212:213], v[212:213], v[152:153]
  v_pk_add_f32 v[210:211], v[210:211], v[202:203]
  v_pk_add_f32 v[212:213], v[212:213], v[154:155]
  v_pk_add_f32 v[210:211], v[210:211], v[204:205]
  v_pk_add_f32 v[212:213], v[212:213], v[156:157]
  v_pk_add_f32 v[210:211], v[210:211], v[206:207]
  s_add_u32 m0, s98, 16384
  v_pk_add_f32 v[212:213], v[212:213], v[158:159]
  v_add_f32 v208, v210, v211
  v_add_f32 v209, v212, v213
  s_nop 1
  v_permlane32_swap_b32 v208, v209
  buffer_load_dwordx4 v13, s[52:55], s62 offen offset:0 lds
  v_add_f32 v208, v208, v209
  v_rcp_f32 v208, v208
  s_nop 0
  v_mov_b32 v209, v208
  s_nop 1
  v_permlane32_swap_b32 v208, v209
  v_pk_mul_f32 v[192:193], v[192:193], v[208:209] op_sel:[0,0] op_sel_hi:[1,0]
  v_pk_mul_f32 v[194:195], v[194:195], v[208:209] op_sel:[0,0] op_sel_hi:[1,0]
  v_pk_mul_f32 v[196:197], v[196:197], v[208:209] op_sel:[0,0] op_sel_hi:[1,0]
  v_pk_mul_f32 v[198:199], v[198:199], v[208:209] op_sel:[0,0] op_sel_hi:[1,0]
  v_pk_mul_f32 v[200:201], v[200:201], v[208:209] op_sel:[0,0] op_sel_hi:[1,0]
  v_pk_mul_f32 v[202:203], v[202:203], v[208:209] op_sel:[0,0] op_sel_hi:[1,0]
  s_waitcnt vmcnt(6)
  s_barrier
  ds_read_b64_tr_b16 a[224:225], v34 offset:0
  ds_read_b64_tr_b16 a[226:227], v34 offset:512
  ds_read_b64_tr_b16 a[228:229], v34 offset:2048
  ds_read_b64_tr_b16 a[230:231], v34 offset:2560
  ds_read_b64_tr_b16 a[232:233], v34 offset:4096
  ds_read_b64_tr_b16 a[234:235], v34 offset:4608
  ds_read_b64_tr_b16 a[236:237], v34 offset:6144
  ds_read_b64_tr_b16 a[238:239], v34 offset:6656
  v_pk_mul_f32 v[204:205], v[204:205], v[208:209] op_sel:[0,0] op_sel_hi:[1,0]
  v_pk_mul_f32 v[206:207], v[206:207], v[208:209] op_sel:[0,0] op_sel_hi:[1,0]
  v_cvt_pk_bf16_f32 v176, v192, v193
  buffer_load_dwordx4 v32, s[52:55], s62 offen offset:1024 lds
  v_cvt_pk_bf16_f32 v177, v194, v195
  v_cvt_pk_bf16_f32 v178, v196, v197
  v_cvt_pk_bf16_f32 v179, v198, v199
  v_cvt_pk_bf16_f32 v180, v200, v201
  v_cvt_pk_bf16_f32 v181, v202, v203
  v_cvt_pk_bf16_f32 v182, v204, v205
  v_cvt_pk_bf16_f32 v183, v206, v207
  v_pk_mul_f32 v[144:145], v[144:145], v[208:209] op_sel:[0,1] op_sel_hi:[1,1]
  v_pk_mul_f32 v[146:147], v[146:147], v[208:209] op_sel:[0,1] op_sel_hi:[1,1]
  v_pk_mul_f32 v[148:149], v[148:149], v[208:209] op_sel:[0,1] op_sel_hi:[1,1]
  v_pk_mul_f32 v[150:151], v[150:151], v[208:209] op_sel:[0,1] op_sel_hi:[1,1]
  v_pk_mul_f32 v[152:153], v[152:153], v[208:209] op_sel:[0,1] op_sel_hi:[1,1]
  v_pk_mul_f32 v[154:155], v[154:155], v[208:209] op_sel:[0,1] op_sel_hi:[1,1]
  v_pk_mul_f32 v[156:157], v[156:157], v[208:209] op_sel:[0,1] op_sel_hi:[1,1]
  v_pk_mul_f32 v[158:159], v[158:159], v[208:209] op_sel:[0,1] op_sel_hi:[1,1]
  v_cvt_pk_bf16_f32 v184, v144, v145
  v_cvt_pk_bf16_f32 v185, v146, v147
  v_cvt_pk_bf16_f32 v186, v148, v149
  v_cvt_pk_bf16_f32 v187, v150, v151
  v_cvt_pk_bf16_f32 v188, v152, v153
  v_cvt_pk_bf16_f32 v189, v154, v155
  v_cvt_pk_bf16_f32 v190, v156, v157
  v_cvt_pk_bf16_f32 v191, v158, v159
  s_waitcnt lgkmcnt(4)
  v_mfma_f32_32x32x16_bf16 v[96:111], a[228:231], a[4:7], 0
  ds_write_b64 v54, v[160:161]
  s_add_u32 m0, s98, 24576
  v_mfma_f32_32x32x16_bf16 v[112:127], a[228:231], a[116:119], 0
  buffer_load_dwordx4 v13, s[52:55], s63 offen offset:0 lds
  v_xor_b32 v50, 16, v54
  ds_read_b64_tr_b16 a[240:241], v34 offset:8192
  ds_read_b64_tr_b16 a[242:243], v34 offset:8704
  v_mfma_f32_32x32x16_bf16 v[96:111], a[224:227], a[0:3], v[96:111]
  ds_write_b64 v50, v[162:163]
  v_xor_b32 v51, 32, v54
  v_mfma_f32_32x32x16_bf16 v[112:127], a[224:227], a[112:115], v[112:127]
  ds_write_b64 v51, v[164:165]
  ds_read_b64_tr_b16 a[244:245], v34 offset:10240
  ds_read_b64_tr_b16 a[246:247], v34 offset:10752
  s_waitcnt lgkmcnt(7)
  v_mfma_f32_32x32x16_bf16 v[96:111], a[236:239], a[12:15], v[96:111]
  buffer_load_dwordx4 v32, s[52:55], s63 offen offset:1024 lds
  v_xor_b32 v50, 48, v54
  v_mfma_f32_32x32x16_bf16 v[112:127], a[236:239], a[124:127], v[112:127]
  ds_write_b64 v50, v[166:167]
  ds_read_b64_tr_b16 a[248:249], v34 offset:12288
  ds_read_b64_tr_b16 a[250:251], v34 offset:12800
  v_mfma_f32_32x32x16_bf16 v[96:111], a[232:235], a[8:11], v[96:111]
  v_xor_b32 v51, 64, v54
  v_mfma_f32_32x32x16_bf16 v[112:127], a[232:235], a[120:123], v[112:127]
  ds_write_b64 v51, v[168:169]
  s_add_u32 m0, s98, 32768
  v_xor_b32 v50, 80, v54
  ds_read_b64_tr_b16 a[252:253], v34 offset:14336
  ds_read_b64_tr_b16 a[254:255], v34 offset:14848
  s_waitcnt lgkmcnt(6)
  v_mfma_f32_32x32x16_bf16 v[96:111], a[244:247], a[20:23], v[96:111]
  buffer_load_dwordx4 v13, s[52:55], s64 offen offset:0 lds
  ds_write_b64 v50, v[170:171]
  v_mfma_f32_32x32x16_bf16 v[112:127], a[244:247], a[132:135], v[112:127]
  v_xor_b32 v51, 96, v54
  ds_read_b64_tr_b16 a[224:225], v34 offset:16384
  ds_read_b64_tr_b16 a[226:227], v34 offset:16896
  v_mfma_f32_32x32x16_bf16 v[96:111], a[240:243], a[16:19], v[96:111]
  ds_write_b64 v51, v[172:173]
  v_mfma_f32_32x32x16_bf16 v[112:127], a[240:243], a[128:131], v[112:127]
  v_xor_b32 v50, 112, v54
  buffer_load_dwordx4 v32, s[52:55], s64 offen offset:1024 lds
  ds_write_b64 v50, v[174:175]
  ds_read_b64_tr_b16 a[228:229], v34 offset:18432
  ds_read_b64_tr_b16 a[230:231], v34 offset:18944
  s_waitcnt lgkmcnt(7)
  v_mfma_f32_32x32x16_bf16 v[96:111], a[252:255], a[28:31], v[96:111]
  ds_write_b64 v55, v[176:177]
  v_mfma_f32_32x32x16_bf16 v[112:127], a[252:255], a[140:143], v[112:127]
  v_xor_b32 v50, 16, v55
  ds_read_b64_tr_b16 a[232:233], v34 offset:20480
  ds_read_b64_tr_b16 a[234:235], v34 offset:20992
  v_mfma_f32_32x32x16_bf16 v[96:111], a[248:251], a[24:27], v[96:111]
  ds_write_b64 v50, v[178:179]
  s_add_u32 m0, s98, 40960
  s_nop 0
  buffer_load_dwordx4 v13, s[52:55], s65 offen offset:0 lds
  v_mfma_f32_32x32x16_bf16 v[112:127], a[248:251], a[136:139], v[112:127]
  v_xor_b32 v51, 32, v55
  ds_write_b64 v51, v[180:181]
  ds_read_b64_tr_b16 a[236:237], v34 offset:22528
  ds_read_b64_tr_b16 a[238:239], v34 offset:23040
  s_waitcnt lgkmcnt(7)
  v_mfma_f32_32x32x16_bf16 v[96:111], a[228:231], a[36:39], v[96:111]
  v_xor_b32 v50, 48, v55
  v_mfma_f32_32x32x16_bf16 v[112:127], a[228:231], a[148:151], v[112:127]
  ds_write_b64 v50, v[182:183]
  ds_read_b64_tr_b16 a[240:241], v34 offset:24576
  ds_read_b64_tr_b16 a[242:243], v34 offset:25088
  v_mfma_f32_32x32x16_bf16 v[96:111], a[224:227], a[32:35], v[96:111]
  buffer_load_dwordx4 v32, s[52:55], s65 offen offset:1024 lds
  v_xor_b32 v51, 64, v55
  v_mfma_f32_32x32x16_bf16 v[112:127], a[224:227], a[144:147], v[112:127]
  ds_write_b64 v51, v[184:185]
  v_xor_b32 v50, 80, v55
  ds_read_b64_tr_b16 a[244:245], v34 offset:26624
  ds_read_b64_tr_b16 a[246:247], v34 offset:27136
  s_waitcnt lgkmcnt(6)
  v_mfma_f32_32x32x16_bf16 v[96:111], a[236:239], a[44:47], v[96:111]
  ds_write_b64 v50, v[186:187]
  v_mfma_f32_32x32x16_bf16 v[112:127], a[236:239], a[156:159], v[112:127]
  s_add_u32 m0, s98, 49152
  v_xor_b32 v51, 96, v55
  buffer_load_dwordx4 v13, s[52:55], s66 offen offset:0 lds
  ds_read_b64_tr_b16 a[248:249], v34 offset:28672
  ds_read_b64_tr_b16 a[250:251], v34 offset:29184
  v_mfma_f32_32x32x16_bf16 v[96:111], a[232:235], a[40:43], v[96:111]
  ds_write_b64 v51, v[188:189]
  v_mfma_f32_32x32x16_bf16 v[112:127], a[232:235], a[152:155], v[112:127]
  v_xor_b32 v50, 112, v55
  ds_write_b64 v50, v[190:191]
  ds_read_b64_tr_b16 a[252:253], v34 offset:30720
  ds_read_b64_tr_b16 a[254:255], v34 offset:31232
  s_waitcnt lgkmcnt(7)
  v_mfma_f32_32x32x16_bf16 v[96:111], a[244:247], a[52:55], v[96:111]
  s_waitcnt vmcnt(13)
  v_cmp_eq_u32 vcc, 0, v46
  buffer_load_dwordx4 v32, s[52:55], s66 offen offset:1024 lds
  v_mfma_f32_32x32x16_bf16 v[112:127], a[244:247], a[164:167], v[112:127]
s_cbranch_vccnz L_nonce1
L_nonce1_back:
  v_readfirstlane_b32 s74, v46
  ds_read_b64_tr_b16 a[224:225], v34 offset:32768
  ds_read_b64_tr_b16 a[226:227], v34 offset:33280
  v_mfma_f32_32x32x16_bf16 v[96:111], a[240:243], a[48:51], v[96:111]
  v_readfirstlane_b32 s75, v47
  v_mfma_f32_32x32x16_bf16 v[112:127], a[240:243], a[160:163], v[112:127]
  v_mov_b32 v192, 0x3f80
  ds_read_b64_tr_b16 a[228:229], v34 offset:34816
  ds_read_b64_tr_b16 a[230:231], v34 offset:35328
  s_waitcnt lgkmcnt(4)
  v_mfma_f32_32x32x16_bf16 v[96:111], a[252:255], a[60:63], v[96:111]
  s_waitcnt lgkmcnt(0)
  s_barrier
  v_mfma_f32_32x32x16_bf16 v[112:127], a[252:255], a[172:175], v[112:127]
  s_add_u32 m0, s12, 57344
  s_nop 0
  buffer_load_dwordx4 v52, s[52:55], s60 offen lds
  ds_read_b64_tr_b16 v[128:129], v58 offset:0
  ds_read_b64_tr_b16 a[232:233], v34 offset:36864
  ds_read_b64_tr_b16 a[234:235], v34 offset:37376
  v_mfma_f32_32x32x16_bf16 v[96:111], a[248:251], a[56:59], v[96:111]
  v_mfma_f32_32x32x16_bf16 v[112:127], a[248:251], a[168:171], v[112:127]
  ds_read_b64_tr_b16 v[130:131], v59 offset:1536
  ds_read_b64_tr_b16 a[236:237], v34 offset:38912
  ds_read_b64_tr_b16 a[238:239], v34 offset:39424
  v_mfma_f32_32x32x16_bf16 v[96:111], a[228:231], a[68:71], v[96:111]
  s_add_u32 m0, s12, 61440
  ds_read_b64_tr_b16 v[132:133], v58 offset:6144
  buffer_load_dwordx4 v52, s[52:55], s61 offen lds
  v_mfma_f32_32x32x16_bf16 v[112:127], a[228:231], a[180:183], v[112:127]
  ds_read_b64_tr_b16 v[134:135], v59 offset:7680
  ds_read_b64_tr_b16 a[240:241], v34 offset:40960
  ds_read_b64_tr_b16 a[242:243], v34 offset:41472
  v_mfma_f32_32x32x16_bf16 v[96:111], a[224:227], a[64:67], v[96:111]
  ds_read_b64_tr_b16 v[136:137], v58 offset:12288
  v_mfma_f32_32x32x16_bf16 v[112:127], a[224:227], a[176:179], v[112:127]
  s_add_u32 m0, s12, 65536
  s_nop 0
  buffer_load_dwordx4 v52, s[52:55], s62 offen lds
  ds_read_b64_tr_b16 a[244:245], v34 offset:43008
  ds_read_b64_tr_b16 a[246:247], v34 offset:43520
  s_waitcnt lgkmcnt(7)
  v_mfma_f32_32x32x16_bf16 v[96:111], a[236:239], a[76:79], v[96:111]
  ds_read_b64_tr_b16 v[138:139], v59 offset:13824
  v_mfma_f32_32x32x16_bf16 v[112:127], a[236:239], a[188:191], v[112:127]
  ds_read_b64_tr_b16 v[140:141], v58 offset:18432
  ds_read_b64_tr_b16 a[248:249], v34 offset:45056
  ds_read_b64_tr_b16 a[250:251], v34 offset:45568
  v_mfma_f32_32x32x16_bf16 v[96:111], a[232:235], a[72:75], v[96:111]
  s_add_u32 m0, s12, 69632
  s_nop 0
  buffer_load_dwordx4 v52, s[52:55], s63 offen lds
  ds_read_b64_tr_b16 v[142:143], v59 offset:19968
  v_mfma_f32_32x32x16_bf16 v[112:127], a[232:235], a[184:187], v[112:127]
  ds_read_b64_tr_b16 a[252:253], v34 offset:47104
  ds_read_b64_tr_b16 a[254:255], v34 offset:47616
  s_waitcnt lgkmcnt(7)
  v_mfma_f32_32x32x16_bf16 v[96:111], a[244:247], a[84:87], v[96:111]
  ds_read_b64_tr_b16 v[144:145], v58 offset:24576
  v_mfma_f32_32x32x16_bf16 v[112:127], a[244:247], a[196:199], v[112:127]
  s_add_u32 m0, s12, 73728
  ds_read_b64_tr_b16 v[146:147], v59 offset:26112
  buffer_load_dwordx4 v52, s[52:55], s64 offen lds
  ds_read_b64_tr_b16 a[224:225], v34 offset:49152
  ds_read_b64_tr_b16 a[226:227], v34 offset:49664
  v_mfma_f32_32x32x16_bf16 v[96:111], a[240:243], a[80:83], v[96:111]
  ds_read_b64_tr_b16 v[148:149], v58 offset:30720
  v_mfma_f32_32x32x16_bf16 v[112:127], a[240:243], a[192:195], v[112:127]
  ds_read_b64_tr_b16 v[150:151], v59 offset:32256
  ds_read_b64_tr_b16 a[228:229], v34 offset:51200
  ds_read_b64_tr_b16 a[230:231], v34 offset:51712
  s_waitcnt lgkmcnt(8)
  v_mfma_f32_32x32x16_bf16 v[96:111], a[252:255], a[92:95], v[96:111]
  s_add_u32 m0, s12, 77824
  s_nop 0
  buffer_load_dwordx4 v52, s[52:55], s65 offen lds
  v_mfma_f32_32x32x16_bf16 v[112:127], a[252:255], a[204:207], v[112:127]
  ds_read_b64_tr_b16 v[152:153], v58 offset:36864
  ds_read_b64_tr_b16 a[232:233], v34 offset:53248
  ds_read_b64_tr_b16 a[234:235], v34 offset:53760
  v_mfma_f32_32x32x16_bf16 v[96:111], a[248:251], a[88:91], v[96:111]
  ds_read_b64_tr_b16 v[154:155], v59 offset:38400
  v_mfma_f32_32x32x16_bf16 v[112:127], a[248:251], a[200:203], v[112:127]
  s_add_u32 m0, s12, 81920
  ds_read_b64_tr_b16 v[156:157], v58 offset:43008
  buffer_load_dwordx4 v52, s[52:55], s66 offen lds
  ds_read_b64_tr_b16 a[236:237], v34 offset:55296
  ds_read_b64_tr_b16 a[238:239], v34 offset:55808
  s_waitcnt lgkmcnt(7)
  v_mfma_f32_32x32x16_bf16 v[96:111], a[228:231], a[100:103], v[96:111]
  v_mfma_f32_32x32x16_bf16 v[112:127], a[228:231], a[212:215], v[112:127]
  ds_read_b64_tr_b16 v[158:159], v59 offset:44544
  v_mfma_f32_32x32x16_bf16 v[96:111], a[224:227], a[96:99], v[96:111]
  v_mfma_f32_32x32x16_bf16 v[112:127], a[224:227], a[208:211], v[112:127]
  s_waitcnt lgkmcnt(1)
  v_mfma_f32_32x32x16_bf16 v[96:111], a[236:239], a[108:111], v[96:111]
  v_mfma_f32_32x32x16_bf16 v[112:127], a[236:239], a[220:223], v[112:127]
  v_mfma_f32_32x32x16_bf16 v[96:111], a[232:235], a[104:107], v[96:111]
  v_mfma_f32_32x32x16_bf16 v[112:127], a[232:235], a[216:219], v[112:127]
  s_nop 10
  v_cvt_pk_bf16_f32 v160, v96, v97
  v_cvt_pk_bf16_f32 v161, v98, v99
  v_cvt_pk_bf16_f32 v162, v100, v101
  v_cvt_pk_bf16_f32 v163, v102, v103
  v_cvt_pk_bf16_f32 v164, v104, v105
  v_cvt_pk_bf16_f32 v165, v106, v107
  v_cvt_pk_bf16_f32 v166, v108, v109
  v_cvt_pk_bf16_f32 v167, v110, v111
  v_cndmask_b32 v166, v166, v192, s[92:93]
  v_cndmask_b32 v167, v167, 0, s[92:93]
  ds_write_b64 v56, v[160:161] offset:256
  v_xor_b32 v50, 16, v56
  ds_write_b64 v50, v[162:163] offset:256
  v_xor_b32 v51, 32, v56
  ds_write_b64 v51, v[164:165] offset:256
  v_xor_b32 v50, 48, v56
  ds_write_b64 v50, v[166:167] offset:256
  v_cvt_pk_bf16_f32 v168, v112, v113
  v_cvt_pk_bf16_f32 v169, v114, v115
  v_cvt_pk_bf16_f32 v170, v116, v117
  v_cvt_pk_bf16_f32 v171, v118, v119
  v_cvt_pk_bf16_f32 v172, v120, v121
  v_cvt_pk_bf16_f32 v173, v122, v123
  v_cvt_pk_bf16_f32 v174, v124, v125
  v_cvt_pk_bf16_f32 v175, v126, v127
  v_cndmask_b32 v174, v174, v192, s[92:93]
  v_cndmask_b32 v175, v175, 0, s[92:93]
  ds_write_b64 v57, v[168:169] offset:256
  v_xor_b32 v50, 16, v57
  ds_write_b64 v50, v[170:171] offset:256
  v_xor_b32 v51, 32, v57
  ds_write_b64 v51, v[172:173] offset:256
  v_xor_b32 v50, 48, v57
  ds_write_b64 v50, v[174:175] offset:256
  s_waitcnt vmcnt(7)
  s_waitcnt lgkmcnt(0)
  s_barrier
  ds_read_b64_tr_b16 v[160:161], v60 offset:256
  ds_read_b64_tr_b16 v[162:163], v61 offset:1792
  ds_read_b64_tr_b16 v[164:165], v60 offset:6400
  ds_read_b64_tr_b16 v[166:167], v61 offset:7936
  ds_read_b64_tr_b16 v[168:169], v60 offset:12544
  ds_read_b64_tr_b16 v[170:171], v61 offset:14080
  ds_read_b64_tr_b16 v[172:173], v60 offset:18688
  ds_read_b64_tr_b16 v[174:175], v61 offset:20224
  ds_read_b64_tr_b16 v[176:177], v60 offset:24832
  ds_read_b64_tr_b16 v[178:179], v61 offset:26368
  ds_read_b64_tr_b16 v[180:181], v60 offset:30976
  ds_read_b64_tr_b16 v[182:183], v61 offset:32512
  ds_read_b64_tr_b16 v[184:185], v60 offset:37120
  ds_read_b64_tr_b16 v[186:187], v61 offset:38656
  ds_read_b64_tr_b16 v[188:189], v60 offset:43264
  ds_read_b64_tr_b16 v[190:191], v61 offset:44800
  ds_read_b64_tr_b16 a[224:225], v35 offset:0
  ds_read_b64_tr_b16 a[226:227], v35 offset:512
  ds_read_b64_tr_b16 a[228:229], v35 offset:2048
  ds_read_b64_tr_b16 a[230:231], v35 offset:2560
  ds_read_b64_tr_b16 a[232:233], v35 offset:4096
  ds_read_b64_tr_b16 a[234:235], v35 offset:4608
  ds_read_b64_tr_b16 a[236:237], v35 offset:6144
  ds_read_b64_tr_b16 a[238:239], v35 offset:6656
  s_waitcnt lgkmcnt(15)
  v_mfma_f32_32x32x16_bf16 v[96:111], v[128:131], v[160:163], 0
  s_waitcnt lgkmcnt(15)
  v_mfma_f32_32x32x16_bf16 v[96:111], v[132:135], v[164:167], v[96:111]
  s_waitcnt lgkmcnt(15)
  v_mfma_f32_32x32x16_bf16 v[96:111], v[136:139], v[168:171], v[96:111]
  s_waitcnt lgkmcnt(15)
  v_mfma_f32_32x32x16_bf16 v[96:111], v[140:143], v[172:175], v[96:111]
  s_waitcnt lgkmcnt(14)
  v_mfma_f32_32x32x16_bf16 v[96:111], v[144:147], v[176:179], v[96:111]
  s_waitcnt lgkmcnt(12)
  v_mfma_f32_32x32x16_bf16 v[96:111], v[148:151], v[180:183], v[96:111]
  s_waitcnt lgkmcnt(10)
  v_mfma_f32_32x32x16_bf16 v[96:111], v[152:155], v[184:187], v[96:111]
  s_waitcnt lgkmcnt(8)
  v_mfma_f32_32x32x16_bf16 v[96:111], v[156:159], v[188:191], v[96:111]
  s_waitcnt lgkmcnt(4)
  v_mfma_f32_32x32x16_bf16 v[64:79], a[228:231], a[4:7], v[64:79]
  v_mfma_f32_32x32x16_bf16 v[80:95], a[228:231], a[116:119], v[80:95]
  s_nop 8
  v_cvt_pk_bf16_f32 v112, v96, v97
  v_cvt_pk_bf16_f32 v113, v98, v99
  v_cvt_pk_bf16_f32 v114, v100, v101
  ds_read_b64_tr_b16 a[240:241], v35 offset:8192
  ds_read_b64_tr_b16 a[242:243], v35 offset:8704
  v_mfma_f32_32x32x16_bf16 v[64:79], a[224:227], a[0:3], v[64:79]
  v_cvt_pk_bf16_f32 v115, v102, v103
  v_cvt_pk_bf16_f32 v116, v104, v105
  v_cvt_pk_bf16_f32 v117, v106, v107
  v_cvt_pk_bf16_f32 v118, v108, v109
  v_cvt_pk_bf16_f32 v119, v110, v111
  buffer_store_dwordx4 v[112:115], v219, s[36:39], s10 offen sc1
  v_mfma_f32_32x32x16_bf16 v[80:95], a[224:227], a[112:115], v[80:95]
  s_add_u32 s10, s10, 16384
  buffer_store_dwordx4 v[116:119], v219, s[36:39], s10 offen sc1
  s_add_u32 s10, s11, 12582912
  s_barrier
  ds_read_b64_tr_b16 a[244:245], v35 offset:10240
  ds_read_b64_tr_b16 a[246:247], v35 offset:10752
  s_waitcnt lgkmcnt(4)
  v_mfma_f32_32x32x16_bf16 v[64:79], a[236:239], a[12:15], v[64:79]
  v_mfma_f32_32x32x16_bf16 v[80:95], a[236:239], a[124:127], v[80:95]
  s_add_u32 m0, s4, 0
  s_add_u32 s9, s18, 0
  ds_read_b64_tr_b16 a[248:249], v35 offset:12288
  ds_read_b64_tr_b16 a[250:251], v35 offset:12800
  v_mfma_f32_32x32x16_bf16 v[64:79], a[232:235], a[8:11], v[64:79]
  buffer_load_dwordx4 v62, s[40:43], s9 offen offset:0 lds
  v_mfma_f32_32x32x16_bf16 v[80:95], a[232:235], a[120:123], v[80:95]
  buffer_load_dwordx4 v63, s[40:43], s9 offen offset:1024 lds
  ds_read_b64_tr_b16 a[252:253], v35 offset:14336
  ds_read_b64_tr_b16 a[254:255], v35 offset:14848
  s_waitcnt lgkmcnt(4)
  v_mfma_f32_32x32x16_bf16 v[64:79], a[244:247], a[20:23], v[64:79]
  v_mfma_f32_32x32x16_bf16 v[80:95], a[244:247], a[132:135], v[80:95]
  buffer_load_dwordx4 v216, s[40:43], s9 offen offset:2048 lds
  ds_read_b64_tr_b16 a[224:225], v35 offset:16384
  ds_read_b64_tr_b16 a[226:227], v35 offset:16896
  v_mfma_f32_32x32x16_bf16 v[64:79], a[240:243], a[16:19], v[64:79]
  v_mfma_f32_32x32x16_bf16 v[80:95], a[240:243], a[128:131], v[80:95]
  buffer_load_dwordx4 v217, s[40:43], s9 offen offset:3072 lds
  ds_read_b64_tr_b16 a[228:229], v35 offset:18432
  ds_read_b64_tr_b16 a[230:231], v35 offset:18944
  s_waitcnt lgkmcnt(4)
  v_mfma_f32_32x32x16_bf16 v[64:79], a[252:255], a[28:31], v[64:79]
  s_add_u32 m0, s4, 4096
  v_mfma_f32_32x32x16_bf16 v[80:95], a[252:255], a[140:143], v[80:95]
  s_add_u32 s9, s18, 28672
  buffer_load_dwordx4 v62, s[40:43], s9 offen offset:0 lds
  ds_read_b64_tr_b16 a[232:233], v35 offset:20480
  ds_read_b64_tr_b16 a[234:235], v35 offset:20992
  v_mfma_f32_32x32x16_bf16 v[64:79], a[248:251], a[24:27], v[64:79]
  v_mfma_f32_32x32x16_bf16 v[80:95], a[248:251], a[136:139], v[80:95]
  buffer_load_dwordx4 v63, s[40:43], s9 offen offset:1024 lds
  ds_read_b64_tr_b16 a[236:237], v35 offset:22528
  ds_read_b64_tr_b16 a[238:239], v35 offset:23040
  s_waitcnt lgkmcnt(4)
  v_mfma_f32_32x32x16_bf16 v[64:79], a[228:231], a[36:39], v[64:79]
  buffer_load_dwordx4 v216, s[40:43], s9 offen offset:2048 lds
  v_mfma_f32_32x32x16_bf16 v[80:95], a[228:231], a[148:151], v[80:95]
  ds_read_b64_tr_b16 a[240:241], v35 offset:24576
  ds_read_b64_tr_b16 a[242:243], v35 offset:25088
  v_mfma_f32_32x32x16_bf16 v[64:79], a[224:227], a[32:35], v[64:79]
  buffer_load_dwordx4 v217, s[40:43], s9 offen offset:3072 lds
  s_waitcnt vmcnt(8)
  buffer_store_dwordx2 v[46:47], v49, s[36:39], s10 offen sc1
  v_mfma_f32_32x32x16_bf16 v[80:95], a[224:227], a[144:147], v[80:95]
  s_add_u32 m0, s4, 8192
  ds_read_b64_tr_b16 a[244:245], v35 offset:26624
  ds_read_b64_tr_b16 a[246:247], v35 offset:27136
  s_waitcnt lgkmcnt(4)
  v_mfma_f32_32x32x16_bf16 v[64:79], a[236:239], a[44:47], v[64:79]
  s_add_u32 s9, s19, 229376
  buffer_load_dwordx4 v62, s[40:43], s9 offen offset:0 lds
  v_mfma_f32_32x32x16_bf16 v[80:95], a[236:239], a[156:159], v[80:95]
  ds_read_b64_tr_b16 a[248:249], v35 offset:28672
  ds_read_b64_tr_b16 a[250:251], v35 offset:29184
  v_mfma_f32_32x32x16_bf16 v[64:79], a[232:235], a[40:43], v[64:79]
  buffer_load_dwordx4 v63, s[40:43], s9 offen offset:1024 lds
  v_mfma_f32_32x32x16_bf16 v[80:95], a[232:235], a[152:155], v[80:95]
  buffer_load_dwordx4 v216, s[40:43], s9 offen offset:2048 lds
  ds_read_b64_tr_b16 a[252:253], v35 offset:30720
  ds_read_b64_tr_b16 a[254:255], v35 offset:31232
  s_waitcnt lgkmcnt(4)
  v_mfma_f32_32x32x16_bf16 v[64:79], a[244:247], a[52:55], v[64:79]
  v_mfma_f32_32x32x16_bf16 v[80:95], a[244:247], a[164:167], v[80:95]
  buffer_load_dwordx4 v217, s[40:43], s9 offen offset:3072 lds
  ds_read_b64_tr_b16 a[224:225], v35 offset:32768
  ds_read_b64_tr_b16 a[226:227], v35 offset:33280
  v_mfma_f32_32x32x16_bf16 v[64:79], a[240:243], a[48:51], v[64:79]
  v_mfma_f32_32x32x16_bf16 v[80:95], a[240:243], a[160:163], v[80:95]
  s_add_u32 m0, s6, 28672
  s_add_u32 s9, s8, 0
  buffer_load_dwordx4 v62, s[44:47], s9 offen offset:0 lds
  ds_read_b64_tr_b16 a[228:229], v35 offset:34816
  ds_read_b64_tr_b16 a[230:231], v35 offset:35328
  s_waitcnt lgkmcnt(4)
  v_mfma_f32_32x32x16_bf16 v[64:79], a[252:255], a[60:63], v[64:79]
  v_mfma_f32_32x32x16_bf16 v[80:95], a[252:255], a[172:175], v[80:95]
  buffer_load_dwordx4 v63, s[44:47], s9 offen offset:1024 lds
  ds_read_b64_tr_b16 a[232:233], v35 offset:36864
  ds_read_b64_tr_b16 a[234:235], v35 offset:37376
  v_mfma_f32_32x32x16_bf16 v[64:79], a[248:251], a[56:59], v[64:79]
  buffer_load_dwordx4 v216, s[44:47], s9 offen offset:2048 lds
  v_mfma_f32_32x32x16_bf16 v[80:95], a[248:251], a[168:171], v[80:95]
  ds_read_b64_tr_b16 a[236:237], v35 offset:38912
  ds_read_b64_tr_b16 a[238:239], v35 offset:39424
  s_waitcnt lgkmcnt(4)
  v_mfma_f32_32x32x16_bf16 v[64:79], a[228:231], a[68:71], v[64:79]
  buffer_load_dwordx4 v217, s[44:47], s9 offen offset:3072 lds
  v_mfma_f32_32x32x16_bf16 v[80:95], a[228:231], a[180:183], v[80:95]
  ds_read_b64_tr_b16 a[240:241], v35 offset:40960
  ds_read_b64_tr_b16 a[242:243], v35 offset:41472
  v_mfma_f32_32x32x16_bf16 v[64:79], a[224:227], a[64:67], v[64:79]
  s_add_u32 m0, s6, 32768
  s_add_u32 s9, s8, 28672
  buffer_load_dwordx4 v62, s[44:47], s9 offen offset:0 lds
  v_mfma_f32_32x32x16_bf16 v[80:95], a[224:227], a[176:179], v[80:95]
  ds_read_b64_tr_b16 a[244:245], v35 offset:43008
  ds_read_b64_tr_b16 a[246:247], v35 offset:43520
  s_waitcnt lgkmcnt(4)
  v_mfma_f32_32x32x16_bf16 v[64:79], a[236:239], a[76:79], v[64:79]
  buffer_load_dwordx4 v63, s[44:47], s9 offen offset:1024 lds
  v_mfma_f32_32x32x16_bf16 v[80:95], a[236:239], a[188:191], v[80:95]
  ds_read_b64_tr_b16 a[248:249], v35 offset:45056
  ds_read_b64_tr_b16 a[250:251], v35 offset:45568
  v_mfma_f32_32x32x16_bf16 v[64:79], a[232:235], a[72:75], v[64:79]
  buffer_load_dwordx4 v216, s[44:47], s9 offen offset:2048 lds
  v_mfma_f32_32x32x16_bf16 v[80:95], a[232:235], a[184:187], v[80:95]
  s_waitcnt vmcnt(7)
  ds_read_b64_tr_b16 v[128:129], v220 offset:0
  ds_read_b64_tr_b16 a[252:253], v35 offset:47104
  ds_read_b64_tr_b16 a[254:255], v35 offset:47616
  s_waitcnt lgkmcnt(5)
  v_mfma_f32_32x32x16_bf16 v[64:79], a[244:247], a[84:87], v[64:79]
  ds_read_b64_tr_b16 v[130:131], v220 offset:1024
  ds_read_b64_tr_b16 v[132:133], v221 offset:0
  ds_read_b64_tr_b16 v[134:135], v221 offset:1024
  v_mfma_f32_32x32x16_bf16 v[80:95], a[244:247], a[196:199], v[80:95]
  ds_read_b64_tr_b16 v[136:137], v220 offset:2048
  ds_read_b64_tr_b16 v[138:139], v220 offset:3072
  ds_read_b64_tr_b16 v[140:141], v221 offset:2048
  ds_read_b64_tr_b16 a[224:225], v35 offset:49152
  ds_read_b64_tr_b16 a[226:227], v35 offset:49664
  v_mfma_f32_32x32x16_bf16 v[64:79], a[240:243], a[80:83], v[64:79]
  ds_read_b64_tr_b16 v[142:143], v221 offset:3072
  ds_read_b64_tr_b16 v[144:145], v220 offset:4096
  ds_read_b64_tr_b16 v[146:147], v220 offset:5120
  v_mfma_f32_32x32x16_bf16 v[80:95], a[240:243], a[192:195], v[80:95]
  ds_read_b64_tr_b16 v[148:149], v221 offset:4096
  ds_read_b64_tr_b16 v[150:151], v221 offset:5120
  ds_read_b64_tr_b16 a[228:229], v35 offset:51200
  ds_read_b64_tr_b16 a[230:231], v35 offset:51712
  s_waitcnt lgkmcnt(15)
  v_mfma_f32_32x32x16_bf16 v[64:79], a[252:255], a[92:95], v[64:79]
  ds_read_b64_tr_b16 v[152:153], v220 offset:6144
  ds_read_b64_tr_b16 v[154:155], v220 offset:7168
  ds_read_b64_tr_b16 v[156:157], v221 offset:6144
  v_mfma_f32_32x32x16_bf16 v[80:95], a[252:255], a[204:207], v[80:95]
  ds_read_b64_tr_b16 v[158:159], v221 offset:7168
  ds_read_b64_tr_b16 v[160:161], v220 offset:8192
  ds_read_b64_tr_b16 v[162:163], v220 offset:9216
  ds_read_b64_tr_b16 a[232:233], v35 offset:53248
  ds_read_b64_tr_b16 a[234:235], v35 offset:53760
  v_mfma_f32_32x32x16_bf16 v[64:79], a[248:251], a[88:91], v[64:79]
  ds_read_b64_tr_b16 v[164:165], v221 offset:8192
  ds_read_b64_tr_b16 v[166:167], v221 offset:9216
  ds_read_b64_tr_b16 v[168:169], v220 offset:10240
  v_mfma_f32_32x32x16_bf16 v[80:95], a[248:251], a[200:203], v[80:95]
  ds_read_b64_tr_b16 v[170:171], v220 offset:11264
  ds_read_b64_tr_b16 v[172:173], v221 offset:10240
  ds_read_b64_tr_b16 v[174:175], v221 offset:11264
  ds_read_b64_tr_b16 a[236:237], v35 offset:55296
  ds_read_b64_tr_b16 a[238:239], v35 offset:55808
  s_waitcnt lgkmcnt(15)
  v_mfma_f32_32x32x16_bf16 v[64:79], a[228:231], a[100:103], v[64:79]
  s_waitcnt lgkmcnt(2)
  s_add_u32 m0, s4, 0
  s_add_u32 s9, s19, 258048
  v_mfma_f32_32x32x16_bf16 v[80:95], a[228:231], a[212:215], v[80:95]
  buffer_load_dwordx4 v62, s[40:43], s9 offen offset:0 lds
  v_mfma_f32_32x32x16_bf16 v[64:79], a[224:227], a[96:99], v[64:79]
  buffer_load_dwordx4 v63, s[40:43], s9 offen offset:1024 lds
  v_mfma_f32_32x32x16_bf16 v[80:95], a[224:227], a[208:211], v[80:95]
  s_waitcnt lgkmcnt(0)
  v_mfma_f32_32x32x16_bf16 v[64:79], a[236:239], a[108:111], v[64:79]
  buffer_load_dwordx4 v216, s[40:43], s9 offen offset:2048 lds
  v_mfma_f32_32x32x16_bf16 v[80:95], a[236:239], a[220:223], v[80:95]
  buffer_load_dwordx4 v217, s[40:43], s9 offen offset:3072 lds
  v_mfma_f32_32x32x16_bf16 v[64:79], a[232:235], a[104:107], v[64:79]
  v_mfma_f32_32x32x16_bf16 v[80:95], a[232:235], a[216:219], v[80:95]
  v_mov_b32 v24, v25
  s_nop 1
  v_mfma_f32_32x32x16_bf16 v[96:111], v[24:27], v[28:31], 0
  s_nop 6
  v_pk_mul_f32 v[192:193], v[64:65], s[90:91]
  v_pk_mul_f32 v[194:195], v[66:67], s[90:91]
  v_exp_f32 v192, v192
  v_exp_f32 v193, v193
  v_exp_f32 v194, v194
  v_exp_f32 v195, v195
  v_pk_fma_f32 v[192:193], v[192:193], v[14:15], v[14:15]
  v_pk_fma_f32 v[194:195], v[194:195], v[14:15], v[14:15]
  v_pk_fma_f32 v[192:193], v[192:193], v[192:193], 0.5 op_sel_hi:[1,1,0]
  v_pk_fma_f32 v[194:195], v[194:195], v[194:195], 0.5 op_sel_hi:[1,1,0]
  v_rcp_f32 v192, v192
  v_rcp_f32 v193, v193
  v_rcp_f32 v194, v194
  v_rcp_f32 v195, v195
  v_pk_fma_f32 v[192:193], v[64:65], v[192:193], v[64:65] neg_lo:[1,0,0] neg_hi:[1,0,0]
  v_pk_fma_f32 v[194:195], v[66:67], v[194:195], v[66:67] neg_lo:[1,0,0] neg_hi:[1,0,0]
  v_cvt_pk_bf16_f32 v200, v192, v193
  v_cvt_pk_bf16_f32 v201, v194, v195
  v_pk_mul_f32 v[196:197], v[68:69], s[90:91]
  v_pk_mul_f32 v[198:199], v[70:71], s[90:91]
  v_exp_f32 v196, v196
  v_exp_f32 v197, v197
  v_exp_f32 v198, v198
  v_exp_f32 v199, v199
  v_pk_fma_f32 v[196:197], v[196:197], v[14:15], v[14:15]
  v_pk_fma_f32 v[198:199], v[198:199], v[14:15], v[14:15]
  v_pk_fma_f32 v[196:197], v[196:197], v[196:197], 0.5 op_sel_hi:[1,1,0]
  v_pk_fma_f32 v[198:199], v[198:199], v[198:199], 0.5 op_sel_hi:[1,1,0]
  v_rcp_f32 v196, v196
  v_rcp_f32 v197, v197
  v_rcp_f32 v198, v198
  v_rcp_f32 v199, v199
  v_pk_fma_f32 v[196:197], v[68:69], v[196:197], v[68:69] neg_lo:[1,0,0] neg_hi:[1,0,0]
  v_pk_fma_f32 v[198:199], v[70:71], v[198:199], v[70:71] neg_lo:[1,0,0] neg_hi:[1,0,0]
  v_cvt_pk_bf16_f32 v202, v196, v197
  v_cvt_pk_bf16_f32 v203, v198, v199
  buffer_store_dwordx4 v[200:203], v44, s[36:39], s13 offen offset:0 sc1
  v_pk_mul_f32 v[192:193], v[72:73], s[90:91]
  v_pk_mul_f32 v[194:195], v[74:75], s[90:91]
  v_exp_f32 v192, v192
  v_exp_f32 v193, v193
  v_exp_f32 v194, v194
  v_exp_f32 v195, v195
  v_pk_fma_f32 v[192:193], v[192:193], v[14:15], v[14:15]
  v_pk_fma_f32 v[194:195], v[194:195], v[14:15], v[14:15]
  v_pk_fma_f32 v[192:193], v[192:193], v[192:193], 0.5 op_sel_hi:[1,1,0]
  v_pk_fma_f32 v[194:195], v[194:195], v[194:195], 0.5 op_sel_hi:[1,1,0]
  v_rcp_f32 v192, v192
  v_rcp_f32 v193, v193
  v_rcp_f32 v194, v194
  v_rcp_f32 v195, v195
  v_pk_fma_f32 v[192:193], v[72:73], v[192:193], v[72:73] neg_lo:[1,0,0] neg_hi:[1,0,0]
  v_pk_fma_f32 v[194:195], v[74:75], v[194:195], v[74:75] neg_lo:[1,0,0] neg_hi:[1,0,0]
  v_cvt_pk_bf16_f32 v204, v192, v193
  v_cvt_pk_bf16_f32 v205, v194, v195
  v_pk_mul_f32 v[196:197], v[76:77], s[90:91]
  v_pk_mul_f32 v[198:199], v[78:79], s[90:91]
  v_exp_f32 v196, v196
  v_exp_f32 v197, v197
  v_exp_f32 v198, v198
  v_exp_f32 v199, v199
  v_pk_fma_f32 v[196:197], v[196:197], v[14:15], v[14:15]
  v_pk_fma_f32 v[198:199], v[198:199], v[14:15], v[14:15]
  v_pk_fma_f32 v[196:197], v[196:197], v[196:197], 0.5 op_sel_hi:[1,1,0]
  v_pk_fma_f32 v[198:199], v[198:199], v[198:199], 0.5 op_sel_hi:[1,1,0]
  v_rcp_f32 v196, v196
  v_rcp_f32 v197, v197
  v_rcp_f32 v198, v198
  v_rcp_f32 v199, v199
  v_pk_fma_f32 v[196:197], v[76:77], v[196:197], v[76:77] neg_lo:[1,0,0] neg_hi:[1,0,0]
  v_pk_fma_f32 v[198:199], v[78:79], v[198:199], v[78:79] neg_lo:[1,0,0] neg_hi:[1,0,0]
  v_cvt_pk_bf16_f32 v206, v196, v197
  v_cvt_pk_bf16_f32 v207, v198, v199
  buffer_store_dwordx4 v[204:207], v44, s[36:39], s13 offen offset:1024 sc1
  v_pk_mul_f32 v[192:193], v[80:81], s[90:91]
  v_pk_mul_f32 v[194:195], v[82:83], s[90:91]
  v_exp_f32 v192, v192
  v_exp_f32 v193, v193
  v_exp_f32 v194, v194
  v_exp_f32 v195, v195
  v_pk_fma_f32 v[192:193], v[192:193], v[14:15], v[14:15]
  v_pk_fma_f32 v[194:195], v[194:195], v[14:15], v[14:15]
  s_add_u32 m0, s4, 4096
  v_pk_fma_f32 v[192:193], v[192:193], v[192:193], 0.5 op_sel_hi:[1,1,0]
  s_add_u32 s9, s18, 57344
  v_pk_fma_f32 v[194:195], v[194:195], v[194:195], 0.5 op_sel_hi:[1,1,0]
  buffer_load_dwordx4 v62, s[40:43], s9 offen offset:0 lds
  v_rcp_f32 v192, v192
  v_rcp_f32 v193, v193
  v_rcp_f32 v194, v194
  buffer_load_dwordx4 v63, s[40:43], s9 offen offset:1024 lds
  v_rcp_f32 v195, v195
  v_pk_fma_f32 v[192:193], v[80:81], v[192:193], v[80:81] neg_lo:[1,0,0] neg_hi:[1,0,0]
  v_pk_fma_f32 v[194:195], v[82:83], v[194:195], v[82:83] neg_lo:[1,0,0] neg_hi:[1,0,0]
  buffer_load_dwordx4 v216, s[40:43], s9 offen offset:2048 lds
  v_cvt_pk_bf16_f32 v200, v192, v193
  v_cvt_pk_bf16_f32 v201, v194, v195
  v_pk_mul_f32 v[196:197], v[84:85], s[90:91]
  v_pk_mul_f32 v[198:199], v[86:87], s[90:91]
  v_exp_f32 v196, v196
  buffer_load_dwordx4 v217, s[40:43], s9 offen offset:3072 lds
  v_exp_f32 v197, v197
  v_exp_f32 v198, v198
  s_add_u32 m0, s4, 8192
  v_exp_f32 v199, v199
  s_add_u32 s9, s18, 86016
  v_pk_fma_f32 v[196:197], v[196:197], v[14:15], v[14:15]
  buffer_load_dwordx4 v62, s[40:43], s9 offen offset:0 lds
  v_pk_fma_f32 v[198:199], v[198:199], v[14:15], v[14:15]
  v_pk_fma_f32 v[196:197], v[196:197], v[196:197], 0.5 op_sel_hi:[1,1,0]
  v_pk_fma_f32 v[198:199], v[198:199], v[198:199], 0.5 op_sel_hi:[1,1,0]
  v_rcp_f32 v196, v196
  buffer_load_dwordx4 v63, s[40:43], s9 offen offset:1024 lds
  v_rcp_f32 v197, v197
  v_rcp_f32 v198, v198
  v_rcp_f32 v199, v199
  buffer_load_dwordx4 v216, s[40:43], s9 offen offset:2048 lds
  v_pk_fma_f32 v[196:197], v[84:85], v[196:197], v[84:85] neg_lo:[1,0,0] neg_hi:[1,0,0]
  v_pk_fma_f32 v[198:199], v[86:87], v[198:199], v[86:87] neg_lo:[1,0,0] neg_hi:[1,0,0]
  v_cvt_pk_bf16_f32 v202, v196, v197
  v_cvt_pk_bf16_f32 v203, v198, v199
  buffer_load_dwordx4 v217, s[40:43], s9 offen offset:3072 lds
  buffer_store_dwordx4 v[200:203], v45, s[36:39], s13 offen offset:0 sc1
  v_pk_mul_f32 v[192:193], v[88:89], s[90:91]
  v_pk_mul_f32 v[194:195], v[90:91], s[90:91]
  v_exp_f32 v192, v192
  v_exp_f32 v193, v193
  v_exp_f32 v194, v194
  s_barrier
  ds_read_b64_tr_b16 a[224:225], v53 offset:0
  ds_read_b64_tr_b16 a[226:227], v53 offset:256
  ds_read_b64_tr_b16 a[228:229], v53 offset:1024
  ds_read_b64_tr_b16 a[230:231], v53 offset:1280
  ds_read_b64_tr_b16 a[232:233], v53 offset:2048
  ds_read_b64_tr_b16 a[234:235], v53 offset:2304
  ds_read_b64_tr_b16 a[236:237], v53 offset:3072
  ds_read_b64_tr_b16 a[238:239], v53 offset:3328
  v_exp_f32 v195, v195
  v_pk_fma_f32 v[192:193], v[192:193], v[14:15], v[14:15]
  v_pk_fma_f32 v[194:195], v[194:195], v[14:15], v[14:15]
  v_pk_fma_f32 v[192:193], v[192:193], v[192:193], 0.5 op_sel_hi:[1,1,0]
  v_pk_fma_f32 v[194:195], v[194:195], v[194:195], 0.5 op_sel_hi:[1,1,0]
  v_rcp_f32 v192, v192
  v_rcp_f32 v193, v193
  v_rcp_f32 v194, v194
  v_rcp_f32 v195, v195
  v_pk_fma_f32 v[192:193], v[88:89], v[192:193], v[88:89] neg_lo:[1,0,0] neg_hi:[1,0,0]
  v_pk_fma_f32 v[194:195], v[90:91], v[194:195], v[90:91] neg_lo:[1,0,0] neg_hi:[1,0,0]
  v_cvt_pk_bf16_f32 v204, v192, v193
  v_cvt_pk_bf16_f32 v205, v194, v195
  v_pk_mul_f32 v[196:197], v[92:93], s[90:91]
  v_pk_mul_f32 v[198:199], v[94:95], s[90:91]
  v_exp_f32 v196, v196
  v_exp_f32 v197, v197
  v_exp_f32 v198, v198
  v_exp_f32 v199, v199
  v_pk_fma_f32 v[196:197], v[196:197], v[14:15], v[14:15]
  v_pk_fma_f32 v[198:199], v[198:199], v[14:15], v[14:15]
  v_pk_fma_f32 v[196:197], v[196:197], v[196:197], 0.5 op_sel_hi:[1,1,0]
  v_pk_fma_f32 v[198:199], v[198:199], v[198:199], 0.5 op_sel_hi:[1,1,0]
  v_rcp_f32 v196, v196
  v_rcp_f32 v197, v197
  v_rcp_f32 v198, v198
  v_rcp_f32 v199, v199
  v_pk_fma_f32 v[196:197], v[92:93], v[196:197], v[92:93] neg_lo:[1,0,0] neg_hi:[1,0,0]
  v_pk_fma_f32 v[198:199], v[94:95], v[198:199], v[94:95] neg_lo:[1,0,0] neg_hi:[1,0,0]
  v_cvt_pk_bf16_f32 v206, v196, v197
  v_cvt_pk_bf16_f32 v207, v198, v199
  buffer_store_dwordx4 v[204:207], v45, s[36:39], s13 offen offset:1024 sc1
  s_waitcnt lgkmcnt(4)
  v_mfma_f32_32x32x16_bf16 v[96:111], a[228:231], a[4:7], v[96:111]
  s_add_u32 m0, s5, 0
  s_add_u32 s9, s19, 286720
  ds_read_b64_tr_b16 a[240:241], v53 offset:4096
  ds_read_b64_tr_b16 a[242:243], v53 offset:4352
  v_mfma_f32_32x32x16_bf16 v[96:111], a[224:227], a[0:3], v[96:111]
  buffer_load_dwordx4 v62, s[40:43], s9 offen offset:0 lds
  ds_read_b64_tr_b16 a[244:245], v53 offset:5120
  ds_read_b64_tr_b16 a[246:247], v53 offset:5376
  s_waitcnt lgkmcnt(4)
  v_mfma_f32_32x32x16_bf16 v[96:111], a[236:239], a[12:15], v[96:111]
  buffer_load_dwordx4 v63, s[40:43], s9 offen offset:1024 lds
  ds_read_b64_tr_b16 a[248:249], v53 offset:6144
  ds_read_b64_tr_b16 a[250:251], v53 offset:6400
  v_mfma_f32_32x32x16_bf16 v[96:111], a[232:235], a[8:11], v[96:111]
  ds_read_b64_tr_b16 a[252:253], v53 offset:7168
  ds_read_b64_tr_b16 a[254:255], v53 offset:7424
  s_waitcnt lgkmcnt(4)
  v_mfma_f32_32x32x16_bf16 v[96:111], a[244:247], a[20:23], v[96:111]
  buffer_load_dwordx4 v216, s[40:43], s9 offen offset:2048 lds
  ds_read_b64_tr_b16 a[224:225], v53 offset:8192
  ds_read_b64_tr_b16 a[226:227], v53 offset:8448
  v_mfma_f32_32x32x16_bf16 v[96:111], a[240:243], a[16:19], v[96:111]
  ds_read_b64_tr_b16 a[228:229], v53 offset:9216
  ds_read_b64_tr_b16 a[230:231], v53 offset:9472
  s_waitcnt lgkmcnt(4)
  v_mfma_f32_32x32x16_bf16 v[96:111], a[252:255], a[28:31], v[96:111]
  buffer_load_dwordx4 v217, s[40:43], s9 offen offset:3072 lds
  ds_read_b64_tr_b16 a[232:233], v53 offset:10240
  ds_read_b64_tr_b16 a[234:235], v53 offset:10496
  v_mfma_f32_32x32x16_bf16 v[96:111], a[248:251], a[24:27], v[96:111]
  s_add_u32 m0, s5, 4096
  ds_read_b64_tr_b16 a[236:237], v53 offset:11264
  ds_read_b64_tr_b16 a[238:239], v53 offset:11520
  s_waitcnt lgkmcnt(4)
  v_mfma_f32_32x32x16_bf16 v[96:111], a[228:231], a[36:39], v[96:111]
  s_add_u32 s9, s19, 315392
  buffer_load_dwordx4 v62, s[40:43], s9 offen offset:0 lds
  ds_read_b64_tr_b16 a[240:241], v53 offset:12288
  ds_read_b64_tr_b16 a[242:243], v53 offset:12544
  v_mfma_f32_32x32x16_bf16 v[96:111], a[224:227], a[32:35], v[96:111]
  ds_read_b64_tr_b16 a[244:245], v53 offset:13312
  ds_read_b64_tr_b16 a[246:247], v53 offset:13568
  s_waitcnt lgkmcnt(4)
  v_mfma_f32_32x32x16_bf16 v[96:111], a[236:239], a[44:47], v[96:111]
  buffer_load_dwordx4 v63, s[40:43], s9 offen offset:1024 lds
  ds_read_b64_tr_b16 a[248:249], v53 offset:14336
  ds_read_b64_tr_b16 a[250:251], v53 offset:14592
  v_mfma_f32_32x32x16_bf16 v[96:111], a[232:235], a[40:43], v[96:111]
  ds_read_b64_tr_b16 a[252:253], v53 offset:15360
  ds_read_b64_tr_b16 a[254:255], v53 offset:15616
  s_waitcnt lgkmcnt(4)
  v_mfma_f32_32x32x16_bf16 v[96:111], a[244:247], a[52:55], v[96:111]
  buffer_load_dwordx4 v216, s[40:43], s9 offen offset:2048 lds
  ds_read_b64_tr_b16 a[224:225], v53 offset:16384
  ds_read_b64_tr_b16 a[226:227], v53 offset:16640
  v_mfma_f32_32x32x16_bf16 v[96:111], a[240:243], a[48:51], v[96:111]
  buffer_load_dwordx4 v217, s[40:43], s9 offen offset:3072 lds
  ds_read_b64_tr_b16 a[228:229], v53 offset:17408
  ds_read_b64_tr_b16 a[230:231], v53 offset:17664
  s_waitcnt lgkmcnt(4)
  v_mfma_f32_32x32x16_bf16 v[96:111], a[252:255], a[60:63], v[96:111]
  ds_read_b64_tr_b16 a[232:233], v53 offset:18432
  ds_read_b64_tr_b16 a[234:235], v53 offset:18688
  v_mfma_f32_32x32x16_bf16 v[96:111], a[248:251], a[56:59], v[96:111]
  s_add_u32 m0, s5, 8192
  s_add_u32 s9, s18, 114688
  ds_read_b64_tr_b16 a[236:237], v53 offset:19456
  ds_read_b64_tr_b16 a[238:239], v53 offset:19712
  s_waitcnt lgkmcnt(4)
  v_mfma_f32_32x32x16_bf16 v[96:111], a[228:231], a[68:71], v[96:111]
  buffer_load_dwordx4 v62, s[40:43], s9 offen offset:0 lds
  s_add_u32 s82, s100, 12910592
  s_waitcnt vmcnt(9)
  buffer_store_dwordx2 v[46:47], v49, s[36:39], s82 offen sc1
  ds_read_b64_tr_b16 a[240:241], v53 offset:20480
  ds_read_b64_tr_b16 a[242:243], v53 offset:20736
  v_mfma_f32_32x32x16_bf16 v[96:111], a[224:227], a[64:67], v[96:111]
  ds_read_b64_tr_b16 a[244:245], v53 offset:21504
  ds_read_b64_tr_b16 a[246:247], v53 offset:21760
  s_waitcnt lgkmcnt(4)
  v_mfma_f32_32x32x16_bf16 v[96:111], a[236:239], a[76:79], v[96:111]
  buffer_load_dwordx4 v63, s[40:43], s9 offen offset:1024 lds
  ds_read_b64_tr_b16 a[248:249], v53 offset:22528
  ds_read_b64_tr_b16 a[250:251], v53 offset:22784
  v_mfma_f32_32x32x16_bf16 v[96:111], a[232:235], a[72:75], v[96:111]
  buffer_load_dwordx4 v216, s[40:43], s9 offen offset:2048 lds
  ds_read_b64_tr_b16 a[252:253], v53 offset:23552
  ds_read_b64_tr_b16 a[254:255], v53 offset:23808
  s_waitcnt lgkmcnt(4)
  v_mfma_f32_32x32x16_bf16 v[96:111], a[244:247], a[84:87], v[96:111]
  ds_read_b64_tr_b16 a[224:225], v53 offset:24576
  ds_read_b64_tr_b16 a[226:227], v53 offset:24832
  v_mfma_f32_32x32x16_bf16 v[96:111], a[240:243], a[80:83], v[96:111]
  buffer_load_dwordx4 v217, s[40:43], s9 offen offset:3072 lds
  ds_read_b64_tr_b16 a[228:229], v53 offset:25600
  ds_read_b64_tr_b16 a[230:231], v53 offset:25856
  s_waitcnt lgkmcnt(4)
  v_mfma_f32_32x32x16_bf16 v[96:111], a[252:255], a[92:95], v[96:111]
  ds_read_b64_tr_b16 a[232:233], v53 offset:26624
  ds_read_b64_tr_b16 a[234:235], v53 offset:26880
  v_mfma_f32_32x32x16_bf16 v[96:111], a[248:251], a[88:91], v[96:111]
  s_add_u32 m0, s5, 12288
  s_add_u32 s9, s18, 143360
  buffer_load_dwordx4 v62, s[40:43], s9 offen offset:0 lds
  ds_read_b64_tr_b16 a[236:237], v53 offset:27648
  ds_read_b64_tr_b16 a[238:239], v53 offset:27904
  s_waitcnt lgkmcnt(4)
  v_mfma_f32_32x32x16_bf16 v[96:111], a[228:231], a[100:103], v[96:111]
  v_mfma_f32_32x32x16_bf16 v[96:111], a[224:227], a[96:99], v[96:111]
  buffer_load_dwordx4 v63, s[40:43], s9 offen offset:1024 lds
  s_waitcnt lgkmcnt(0)
  v_mfma_f32_32x32x16_bf16 v[96:111], a[236:239], a[108:111], v[96:111]
  v_mfma_f32_32x32x16_bf16 v[96:111], a[232:235], a[104:107], v[96:111]
  s_lshl2_add_u32 s76, s86, s56
  s_lshl_b32 s76, s76, 9
  s_add_u32 s76, s76, 12582912
  s_add_u32 s20, s26, s76
  s_addc_u32 s21, s27, 0
  s_barrier
  s_cmp_eq_u32 s87, 7
  s_cbranch_scc1 L_idle
  s_load_dwordx2 s[60:61], s[20:21], 0x20000 glc
  s_load_dwordx2 s[62:63], s[20:21], 0x20080 glc
  s_load_dwordx2 s[64:65], s[20:21], 0x20100 glc
  s_load_dwordx2 s[66:67], s[20:21], 0x20180 glc
  s_nop 1
  v_pk_mul_f32 v[192:193], v[96:97], s[90:91]
  v_pk_mul_f32 v[194:195], v[98:99], s[90:91]
  v_exp_f32 v192, v192
  v_exp_f32 v193, v193
  v_exp_f32 v194, v194
  v_exp_f32 v195, v195
  v_pk_fma_f32 v[192:193], v[192:193], v[14:15], v[14:15]
  v_pk_fma_f32 v[194:195], v[194:195], v[14:15], v[14:15]
  v_pk_fma_f32 v[192:193], v[192:193], v[192:193], 0.5 op_sel_hi:[1,1,0]
  v_pk_fma_f32 v[194:195], v[194:195], v[194:195], 0.5 op_sel_hi:[1,1,0]
  v_rcp_f32 v192, v192
  v_rcp_f32 v193, v193
  v_rcp_f32 v194, v194
  v_rcp_f32 v195, v195
  v_pk_fma_f32 v[192:193], v[96:97], v[192:193], v[96:97] neg_lo:[1,0,0] neg_hi:[1,0,0]
  v_pk_fma_f32 v[194:195], v[98:99], v[194:195], v[98:99] neg_lo:[1,0,0] neg_hi:[1,0,0]
  v_cvt_pk_bf16_f32 v200, v192, v193
  v_cvt_pk_bf16_f32 v201, v194, v195
  v_pk_mul_f32 v[196:197], v[100:101], s[90:91]
  v_pk_mul_f32 v[198:199], v[102:103], s[90:91]
  v_exp_f32 v196, v196
  v_exp_f32 v197, v197
  v_exp_f32 v198, v198
  v_exp_f32 v199, v199
  v_pk_fma_f32 v[196:197], v[196:197], v[14:15], v[14:15]
  v_pk_fma_f32 v[198:199], v[198:199], v[14:15], v[14:15]
  v_pk_fma_f32 v[196:197], v[196:197], v[196:197], 0.5 op_sel_hi:[1,1,0]
  v_pk_fma_f32 v[198:199], v[198:199], v[198:199], 0.5 op_sel_hi:[1,1,0]
  v_rcp_f32 v196, v196
  v_rcp_f32 v197, v197
  v_rcp_f32 v198, v198
  v_rcp_f32 v199, v199
  v_pk_fma_f32 v[196:197], v[100:101], v[196:197], v[100:101] neg_lo:[1,0,0] neg_hi:[1,0,0]
  v_pk_fma_f32 v[198:199], v[102:103], v[198:199], v[102:103] neg_lo:[1,0,0] neg_hi:[1,0,0]
  v_cvt_pk_bf16_f32 v202, v196, v197
  v_cvt_pk_bf16_f32 v203, v198, v199
  buffer_store_dwordx4 v[200:203], v44, s[36:39], s15 offen offset:0 sc1
  v_pk_mul_f32 v[192:193], v[104:105], s[90:91]
  v_pk_mul_f32 v[194:195], v[106:107], s[90:91]
  v_exp_f32 v192, v192
  v_exp_f32 v193, v193
  v_exp_f32 v194, v194
  v_exp_f32 v195, v195
  v_pk_fma_f32 v[192:193], v[192:193], v[14:15], v[14:15]
  v_pk_fma_f32 v[194:195], v[194:195], v[14:15], v[14:15]
  v_pk_fma_f32 v[192:193], v[192:193], v[192:193], 0.5 op_sel_hi:[1,1,0]
  v_pk_fma_f32 v[194:195], v[194:195], v[194:195], 0.5 op_sel_hi:[1,1,0]
  v_rcp_f32 v192, v192
  v_rcp_f32 v193, v193
  v_rcp_f32 v194, v194
  v_rcp_f32 v195, v195
  v_pk_fma_f32 v[192:193], v[104:105], v[192:193], v[104:105] neg_lo:[1,0,0] neg_hi:[1,0,0]
  v_pk_fma_f32 v[194:195], v[106:107], v[194:195], v[106:107] neg_lo:[1,0,0] neg_hi:[1,0,0]
  v_cvt_pk_bf16_f32 v204, v192, v193
  v_cvt_pk_bf16_f32 v205, v194, v195
  v_pk_mul_f32 v[196:197], v[108:109], s[90:91]
  v_pk_mul_f32 v[198:199], v[110:111], s[90:91]
  v_exp_f32 v196, v196
  v_exp_f32 v197, v197
  v_exp_f32 v198, v198
  v_exp_f32 v199, v199
  v_pk_fma_f32 v[196:197], v[196:197], v[14:15], v[14:15]
  v_pk_fma_f32 v[198:199], v[198:199], v[14:15], v[14:15]
  v_pk_fma_f32 v[196:197], v[196:197], v[196:197], 0.5 op_sel_hi:[1,1,0]
  v_pk_fma_f32 v[198:199], v[198:199], v[198:199], 0.5 op_sel_hi:[1,1,0]
  v_rcp_f32 v196, v196
  v_rcp_f32 v197, v197
  v_rcp_f32 v198, v198
  v_rcp_f32 v199, v199
  v_pk_fma_f32 v[196:197], v[108:109], v[196:197], v[108:109] neg_lo:[1,0,0] neg_hi:[1,0,0]
  v_pk_fma_f32 v[198:199], v[110:111], v[198:199], v[110:111] neg_lo:[1,0,0] neg_hi:[1,0,0]
  v_cvt_pk_bf16_f32 v206, v196, v197
  v_cvt_pk_bf16_f32 v207, v198, v199
  buffer_store_dwordx4 v[204:207], v44, s[36:39], s15 offen offset:1024 sc1
  s_waitcnt lgkmcnt(0)
  s_cmp_eq_u64 s[60:61], s[74:75]
  s_cselect_b64 s[62:63], s[62:63], 0
  s_cmp_eq_u64 s[62:63], s[74:75]
  s_cselect_b64 s[64:65], s[64:65], 0
  s_cmp_eq_u64 s[64:65], s[74:75]
  s_cselect_b64 s[66:67], s[66:67], 0
  s_cmp_eq_u64 s[66:67], s[74:75]
  s_cbranch_scc0 L_poll2
L_poll2_back:
  s_add_u32 s16, s89, 0
  buffer_load_dwordx4 a[0:3], v228, s[36:39], s16 offen offset:0 sc1
  buffer_load_dwordx4 a[4:7], v229, s[36:39], s16 offen offset:0 sc1
  buffer_load_dwordx4 a[8:11], v228, s[36:39], s16 offen offset:1024 sc1
  buffer_load_dwordx4 a[12:15], v229, s[36:39], s16 offen offset:1024 sc1
  buffer_load_dwordx4 a[16:19], v228, s[36:39], s16 offen offset:2048 sc1
  buffer_load_dwordx4 a[20:23], v229, s[36:39], s16 offen offset:2048 sc1
  buffer_load_dwordx4 a[24:27], v228, s[36:39], s16 offen offset:3072 sc1
  buffer_load_dwordx4 a[28:31], v229, s[36:39], s16 offen offset:3072 sc1
  ds_read_b64_tr_b16 a[112:113], v220 offset:0
  ds_read_b64_tr_b16 a[114:115], v220 offset:1024
  ds_read_b64_tr_b16 a[116:117], v221 offset:0
  ds_read_b64_tr_b16 a[118:119], v221 offset:1024
  ds_read_b64_tr_b16 a[120:121], v220 offset:2048
  ds_read_b64_tr_b16 a[122:123], v220 offset:3072
  ds_read_b64_tr_b16 a[124:125], v221 offset:2048
  ds_read_b64_tr_b16 a[126:127], v221 offset:3072
  ds_read_b64_tr_b16 a[128:129], v220 offset:4096
  ds_read_b64_tr_b16 a[130:131], v220 offset:5120
  ds_read_b64_tr_b16 a[132:133], v221 offset:4096
  ds_read_b64_tr_b16 a[134:135], v221 offset:5120
  ds_read_b64_tr_b16 a[136:137], v220 offset:6144
  ds_read_b64_tr_b16 a[138:139], v220 offset:7168
  ds_read_b64_tr_b16 a[140:141], v221 offset:6144
  ds_read_b64_tr_b16 a[142:143], v221 offset:7168
  ds_read_b64_tr_b16 a[144:145], v220 offset:8192
  ds_read_b64_tr_b16 a[146:147], v220 offset:9216
  ds_read_b64_tr_b16 a[148:149], v221 offset:8192
  ds_read_b64_tr_b16 a[150:151], v221 offset:9216
  ds_read_b64_tr_b16 a[152:153], v220 offset:10240
  ds_read_b64_tr_b16 a[154:155], v220 offset:11264
  ds_read_b64_tr_b16 a[156:157], v221 offset:10240
  ds_read_b64_tr_b16 a[158:159], v221 offset:11264
  s_waitcnt lgkmcnt(0)
  s_load_dwordx2 s[60:61], s[20:21], 0x50000 glc
  s_load_dwordx2 s[62:63], s[20:21], 0x50080 glc
  s_load_dwordx2 s[64:65], s[20:21], 0x50100 glc
  s_load_dwordx2 s[66:67], s[20:21], 0x50180 glc
  s_add_u32 s82, s100, 13172736
  s_waitcnt vmcnt(8)
  buffer_store_dwordx2 v[46:47], v49, s[36:39], s82 offen sc1
  s_mul_i32 s12, s56, 16448
  s_lshl_b32 s77, s86, 8
  s_add_u32 s12, s12, s77
  s_add_u32 s12, s12, 12058624
  v_lshrrev_b32 v5, 1, v1
  v_and_b32 v5, 28, v5
  s_sub_u32 s16, 16384, s89
  buffer_load_dwordx4 a[32:35], v228, s[36:39], s16 offen offset:0 sc1
  buffer_load_dwordx4 a[36:39], v229, s[36:39], s16 offen offset:0 sc1
  s_waitcnt vmcnt(9)
  v_mfma_f32_32x32x16_bf16 v[112:127], v[132:135], a[4:7], 0
  s_add_u32 m0, s4, 0
  s_add_u32 s9, s18, 157696
  buffer_load_dwordx4 v62, s[40:43], s9 offen offset:0 lds
  buffer_load_dwordx4 v63, s[40:43], s9 offen offset:1024 lds
  v_mfma_f32_32x32x16_bf16 v[80:95], v[128:131], a[4:7], 0
  s_add_u32 m0, s4, 2048
  s_add_u32 s9, s19, 344064
  buffer_load_dwordx4 v62, s[40:43], s9 offen offset:0 lds
  v_mfma_f32_32x32x16_bf16 v[96:111], v[132:135], a[0:3], 0
  buffer_load_dwordx4 v63, s[40:43], s9 offen offset:1024 lds
  buffer_load_dwordx4 a[40:43], v228, s[36:39], s16 offen offset:1024 sc1
  v_mfma_f32_32x32x16_bf16 v[64:79], v[128:131], a[0:3], 0
  buffer_load_dwordx4 a[44:47], v229, s[36:39], s16 offen offset:1024 sc1
  s_waitcnt vmcnt(13)
  v_mfma_f32_32x32x16_bf16 v[112:127], v[140:143], a[12:15], v[112:127]
  buffer_load_dwordx4 a[48:51], v228, s[36:39], s16 offen offset:2048 sc1
  v_mfma_f32_32x32x16_bf16 v[80:95], v[136:139], a[12:15], v[80:95]
  v_mfma_f32_32x32x16_bf16 v[96:111], v[140:143], a[8:11], v[96:111]
  buffer_load_dwordx4 a[52:55], v229, s[36:39], s16 offen offset:2048 sc1
  v_mfma_f32_32x32x16_bf16 v[64:79], v[136:139], a[8:11], v[64:79]
  s_waitcnt vmcnt(13)
  v_mfma_f32_32x32x16_bf16 v[112:127], v[148:151], a[20:23], v[112:127]
  s_add_u32 m0, s4, 4096
  s_add_u32 s9, s19, 358400
  buffer_load_dwordx4 v62, s[40:43], s9 offen offset:0 lds
  buffer_load_dwordx4 v63, s[40:43], s9 offen offset:1024 lds
  v_mfma_f32_32x32x16_bf16 v[80:95], v[144:147], a[20:23], v[80:95]
  buffer_load_dwordx4 v216, s[40:43], s9 offen offset:2048 lds
  v_mfma_f32_32x32x16_bf16 v[96:111], v[148:151], a[16:19], v[96:111]
  buffer_load_dwordx4 v217, s[40:43], s9 offen offset:3072 lds
  buffer_load_dwordx4 a[56:59], v228, s[36:39], s16 offen offset:3072 sc1
  v_mfma_f32_32x32x16_bf16 v[64:79], v[144:147], a[16:19], v[64:79]
  buffer_load_dwordx4 a[60:63], v229, s[36:39], s16 offen offset:3072 sc1
  s_waitcnt vmcnt(17)
  v_mfma_f32_32x32x16_bf16 v[112:127], v[156:159], a[28:31], v[112:127]
  s_waitcnt lgkmcnt(0)
  s_cmp_eq_u64 s[60:61], s[74:75]
  s_cselect_b64 s[62:63], s[62:63], 0
  s_cmp_eq_u64 s[62:63], s[74:75]
  s_cselect_b64 s[64:65], s[64:65], 0
  s_cmp_eq_u64 s[64:65], s[74:75]
  s_cselect_b64 s[66:67], s[66:67], 0
  s_cmp_eq_u64 s[66:67], s[74:75]
  s_cbranch_scc0 L_poll3
L_poll3_back:
  v_mfma_f32_32x32x16_bf16 v[80:95], v[152:155], a[28:31], v[80:95]
  s_add_u32 s16, s89, 4096
  buffer_load_dwordx4 a[0:3], v228, s[36:39], s16 offen offset:0 sc1
  v_mfma_f32_32x32x16_bf16 v[96:111], v[156:159], a[24:27], v[96:111]
  buffer_load_dwordx4 a[4:7], v229, s[36:39], s16 offen offset:0 sc1
  v_mfma_f32_32x32x16_bf16 v[64:79], v[152:155], a[24:27], v[64:79]
  s_waitcnt vmcnt(16)
  v_mfma_f32_32x32x16_bf16 v[112:127], v[164:167], a[36:39], v[112:127]
  s_add_u32 m0, s4, 8192
  s_add_u32 s9, s19, 387072
  buffer_load_dwordx4 v62, s[40:43], s9 offen offset:0 lds
  buffer_load_dwordx4 v63, s[40:43], s9 offen offset:1024 lds
  v_mfma_f32_32x32x16_bf16 v[80:95], v[160:163], a[36:39], v[80:95]
  s_add_u32 m0, s4, 10240
  s_add_u32 s9, s7, 172032
  buffer_load_dwordx4 v62, s[40:43], s9 offen offset:0 lds
  v_mfma_f32_32x32x16_bf16 v[96:111], v[164:167], a[32:35], v[96:111]
  buffer_load_dwordx4 v63, s[40:43], s9 offen offset:1024 lds
  buffer_load_dwordx4 a[8:11], v228, s[36:39], s16 offen offset:1024 sc1
  v_mfma_f32_32x32x16_bf16 v[64:79], v[160:163], a[32:35], v[64:79]
  buffer_load_dwordx4 a[12:15], v229, s[36:39], s16 offen offset:1024 sc1
  s_waitcnt vmcnt(16)
  v_mfma_f32_32x32x16_bf16 v[112:127], v[172:175], a[44:47], v[112:127]
  buffer_load_dwordx4 a[16:19], v228, s[36:39], s16 offen offset:2048 sc1
  v_mfma_f32_32x32x16_bf16 v[80:95], v[168:171], a[44:47], v[80:95]
  v_mfma_f32_32x32x16_bf16 v[96:111], v[172:175], a[40:43], v[96:111]
  buffer_load_dwordx4 a[20:23], v229, s[36:39], s16 offen offset:2048 sc1
  v_mfma_f32_32x32x16_bf16 v[64:79], v[168:171], a[40:43], v[64:79]
  s_waitcnt vmcnt(16)
  v_mfma_f32_32x32x16_bf16 v[112:127], a[116:119], a[52:55], v[112:127]
  buffer_load_dwordx4 a[24:27], v228, s[36:39], s16 offen offset:3072 sc1
  v_mfma_f32_32x32x16_bf16 v[80:95], a[112:115], a[52:55], v[80:95]
  buffer_load_dwordx4 a[28:31], v229, s[36:39], s16 offen offset:3072 sc1
  v_mfma_f32_32x32x16_bf16 v[96:111], a[116:119], a[48:51], v[96:111]
  s_load_dwordx2 s[60:61], s[20:21], 0x80000 glc
  v_mfma_f32_32x32x16_bf16 v[64:79], a[112:115], a[48:51], v[64:79]
  s_load_dwordx2 s[62:63], s[20:21], 0x80080 glc
  s_load_dwordx2 s[64:65], s[20:21], 0x80100 glc
  s_load_dwordx2 s[66:67], s[20:21], 0x80180 glc
  s_waitcnt vmcnt(12)
  v_mfma_f32_32x32x16_bf16 v[112:127], a[124:127], a[60:63], v[112:127]
  s_add_u32 m0, s6, 0
  s_add_u32 s9, s3, 50176
  buffer_load_dwordx4 v62, s[44:47], s9 offen offset:0 lds
  buffer_load_dwordx4 v63, s[44:47], s9 offen offset:1024 lds
  buffer_load_dwordx4 v216, s[44:47], s9 offen offset:2048 lds
  v_mfma_f32_32x32x16_bf16 v[80:95], a[120:123], a[60:63], v[80:95]
  buffer_load_dwordx4 v217, s[44:47], s9 offen offset:3072 lds
  s_add_u32 m0, s6, 4096
  s_add_u32 s9, s3, 78848
  buffer_load_dwordx4 v62, s[44:47], s9 offen offset:0 lds
  v_mfma_f32_32x32x16_bf16 v[96:111], a[124:127], a[56:59], v[96:111]
  buffer_load_dwordx4 v63, s[44:47], s9 offen offset:1024 lds
  buffer_load_dwordx4 v216, s[44:47], s9 offen offset:2048 lds
  v_mfma_f32_32x32x16_bf16 v[64:79], a[120:123], a[56:59], v[64:79]
  s_sub_u32 s16, 20480, s89
  buffer_load_dwordx4 a[32:35], v228, s[36:39], s16 offen offset:0 sc1
  buffer_load_dwordx4 a[36:39], v229, s[36:39], s16 offen offset:0 sc1
  s_waitcnt vmcnt(19)
  v_mfma_f32_32x32x16_bf16 v[112:127], a[132:135], a[4:7], v[112:127]
  buffer_load_dwordx4 a[40:43], v228, s[36:39], s16 offen offset:1024 sc1
  v_mfma_f32_32x32x16_bf16 v[80:95], a[128:131], a[4:7], v[80:95]
  v_mfma_f32_32x32x16_bf16 v[96:111], a[132:135], a[0:3], v[96:111]
  buffer_load_dwordx4 a[44:47], v229, s[36:39], s16 offen offset:1024 sc1
  v_mfma_f32_32x32x16_bf16 v[64:79], a[128:131], a[0:3], v[64:79]
  s_waitcnt vmcnt(15)
  v_mfma_f32_32x32x16_bf16 v[112:127], a[140:143], a[12:15], v[112:127]
  buffer_load_dwordx4 a[48:51], v228, s[36:39], s16 offen offset:2048 sc1
  v_mfma_f32_32x32x16_bf16 v[80:95], a[136:139], a[12:15], v[80:95]
  v_mfma_f32_32x32x16_bf16 v[96:111], a[140:143], a[8:11], v[96:111]
  buffer_load_dwordx4 a[52:55], v229, s[36:39], s16 offen offset:2048 sc1
  v_mfma_f32_32x32x16_bf16 v[64:79], a[136:139], a[8:11], v[64:79]
  s_waitcnt vmcnt(15)
  v_mfma_f32_32x32x16_bf16 v[112:127], a[148:151], a[20:23], v[112:127]
  buffer_load_dwordx4 a[56:59], v228, s[36:39], s16 offen offset:3072 sc1
  buffer_load_dwordx4 a[60:63], v229, s[36:39], s16 offen offset:3072 sc1
  v_mfma_f32_32x32x16_bf16 v[80:95], a[144:147], a[20:23], v[80:95]
  ds_read_b64_tr_b16 a[64:65], v222 offset:0
  ds_read_b64_tr_b16 a[66:67], v222 offset:1024
  ds_read_b64_tr_b16 a[68:69], v223 offset:0
  ds_read_b64_tr_b16 a[70:71], v223 offset:1024
  ds_read_b64_tr_b16 a[72:73], v222 offset:2048
  ds_read_b64_tr_b16 a[74:75], v222 offset:3072
  ds_read_b64_tr_b16 a[76:77], v223 offset:2048
  ds_read_b64_tr_b16 a[78:79], v223 offset:3072
  v_mfma_f32_32x32x16_bf16 v[96:111], a[148:151], a[16:19], v[96:111]
  ds_read_b64_tr_b16 a[80:81], v222 offset:4096
  ds_read_b64_tr_b16 a[82:83], v222 offset:5120
  ds_read_b64_tr_b16 a[84:85], v223 offset:4096
  ds_read_b64_tr_b16 a[86:87], v223 offset:5120
  ds_read_b64_tr_b16 a[88:89], v222 offset:6144
  ds_read_b64_tr_b16 a[90:91], v222 offset:7168
  ds_read_b64_tr_b16 a[92:93], v223 offset:6144
  ds_read_b64_tr_b16 a[94:95], v223 offset:7168
  v_mfma_f32_32x32x16_bf16 v[64:79], a[144:147], a[16:19], v[64:79]
  ds_read_b64_tr_b16 a[96:97], v222 offset:8192
  ds_read_b64_tr_b16 a[98:99], v222 offset:9216
  ds_read_b64_tr_b16 a[100:101], v223 offset:8192
  ds_read_b64_tr_b16 a[102:103], v223 offset:9216
  ds_read_b64_tr_b16 a[104:105], v222 offset:10240
  ds_read_b64_tr_b16 a[106:107], v222 offset:11264
  ds_read_b64_tr_b16 a[108:109], v223 offset:10240
  ds_read_b64_tr_b16 a[110:111], v223 offset:11264
  s_waitcnt vmcnt(15)
  v_mfma_f32_32x32x16_bf16 v[112:127], a[156:159], a[28:31], v[112:127]
  s_waitcnt lgkmcnt(0)
  s_cmp_eq_u64 s[60:61], s[74:75]
  s_cselect_b64 s[62:63], s[62:63], 0
  s_cmp_eq_u64 s[62:63], s[74:75]
  s_cselect_b64 s[64:65], s[64:65], 0
  s_cmp_eq_u64 s[64:65], s[74:75]
  s_cselect_b64 s[66:67], s[66:67], 0
  s_cmp_eq_u64 s[66:67], s[74:75]
  s_cbranch_scc0 L_poll4
L_poll4_back:
  v_mfma_f32_32x32x16_bf16 v[80:95], a[152:155], a[28:31], v[80:95]
  s_add_u32 s16, s89, 8192
  buffer_load_dwordx4 a[0:3], v228, s[36:39], s16 offen offset:0 sc1
  v_mfma_f32_32x32x16_bf16 v[96:111], a[156:159], a[24:27], v[96:111]
  buffer_load_dwordx4 a[4:7], v229, s[36:39], s16 offen offset:0 sc1
  v_mfma_f32_32x32x16_bf16 v[64:79], a[152:155], a[24:27], v[64:79]
  s_waitcnt vmcnt(8)
  v_mfma_f32_32x32x16_bf16 v[112:127], a[68:71], a[36:39], v[112:127]
  buffer_load_dwordx4 a[8:11], v228, s[36:39], s16 offen offset:1024 sc1
  buffer_load_dwordx4 a[12:15], v229, s[36:39], s16 offen offset:1024 sc1
  v_mfma_f32_32x32x16_bf16 v[80:95], a[64:67], a[36:39], v[80:95]
  ds_read_b64_tr_b16 a[160:161], v222 offset:12288
  ds_read_b64_tr_b16 a[162:163], v222 offset:13312
  ds_read_b64_tr_b16 a[164:165], v223 offset:12288
  ds_read_b64_tr_b16 a[166:167], v223 offset:13312
  ds_read_b64_tr_b16 a[168:169], v220 offset:0
  ds_read_b64_tr_b16 a[170:171], v220 offset:1024
  ds_read_b64_tr_b16 a[172:173], v221 offset:0
  ds_read_b64_tr_b16 a[174:175], v221 offset:1024
  v_mfma_f32_32x32x16_bf16 v[96:111], a[68:71], a[32:35], v[96:111]
  ds_read_b64_tr_b16 a[176:177], v220 offset:2048
  ds_read_b64_tr_b16 a[178:179], v220 offset:3072
  ds_read_b64_tr_b16 a[180:181], v221 offset:2048
  ds_read_b64_tr_b16 a[182:183], v221 offset:3072
  ds_read_b64_tr_b16 a[184:185], v220 offset:4096
  ds_read_b64_tr_b16 a[186:187], v220 offset:5120
  ds_read_b64_tr_b16 a[188:189], v221 offset:4096
  ds_read_b64_tr_b16 a[190:191], v221 offset:5120
  v_mfma_f32_32x32x16_bf16 v[64:79], a[64:67], a[32:35], v[64:79]
  ds_read_b64_tr_b16 a[192:193], v220 offset:6144
  ds_read_b64_tr_b16 a[194:195], v220 offset:7168
  ds_read_b64_tr_b16 a[196:197], v221 offset:6144
  ds_read_b64_tr_b16 a[198:199], v221 offset:7168
  ds_read_b64_tr_b16 a[200:201], v220 offset:8192
  ds_read_b64_tr_b16 a[202:203], v220 offset:9216
  ds_read_b64_tr_b16 a[204:205], v221 offset:8192
  ds_read_b64_tr_b16 a[206:207], v221 offset:9216
  s_waitcnt vmcnt(8)
  v_mfma_f32_32x32x16_bf16 v[112:127], a[76:79], a[44:47], v[112:127]
  s_waitcnt lgkmcnt(0)
  s_add_u32 m0, s5, 0
  s_add_u32 s9, s7, 186368
  buffer_load_dwordx4 v62, s[40:43], s9 offen offset:0 lds
  buffer_load_dwordx4 v63, s[40:43], s9 offen offset:1024 lds
  v_mfma_f32_32x32x16_bf16 v[80:95], a[72:75], a[44:47], v[80:95]
  buffer_load_dwordx4 v216, s[40:43], s9 offen offset:2048 lds
  buffer_load_dwordx4 v217, s[40:43], s9 offen offset:3072 lds
  v_mfma_f32_32x32x16_bf16 v[96:111], a[76:79], a[40:43], v[96:111]
  s_add_u32 m0, s5, 4096
  s_add_u32 s9, s7, 215040
  buffer_load_dwordx4 v62, s[40:43], s9 offen offset:0 lds
  buffer_load_dwordx4 v63, s[40:43], s9 offen offset:1024 lds
  v_mfma_f32_32x32x16_bf16 v[64:79], a[72:75], a[40:43], v[64:79]
  buffer_load_dwordx4 a[16:19], v228, s[36:39], s16 offen offset:2048 sc1
  buffer_load_dwordx4 a[20:23], v229, s[36:39], s16 offen offset:2048 sc1
  s_waitcnt vmcnt(14)
  v_mfma_f32_32x32x16_bf16 v[112:127], a[84:87], a[52:55], v[112:127]
  buffer_load_dwordx4 a[24:27], v228, s[36:39], s16 offen offset:3072 sc1
  v_mfma_f32_32x32x16_bf16 v[80:95], a[80:83], a[52:55], v[80:95]
  buffer_load_dwordx4 a[28:31], v229, s[36:39], s16 offen offset:3072 sc1
  v_mfma_f32_32x32x16_bf16 v[96:111], a[84:87], a[48:51], v[96:111]
  s_load_dwordx2 s[60:61], s[20:21], 0x90000 glc
  v_mfma_f32_32x32x16_bf16 v[64:79], a[80:83], a[48:51], v[64:79]
  s_load_dwordx2 s[62:63], s[20:21], 0x90080 glc
  s_load_dwordx2 s[64:65], s[20:21], 0x90100 glc
  s_load_dwordx2 s[66:67], s[20:21], 0x90180 glc
  s_waitcnt vmcnt(14)
  v_mfma_f32_32x32x16_bf16 v[112:127], a[92:95], a[60:63], v[112:127]
  s_sub_u32 s16, 24576, s89
  buffer_load_dwordx4 a[32:35], v228, s[36:39], s16 offen offset:0 sc1
  v_mfma_f32_32x32x16_bf16 v[80:95], a[88:91], a[60:63], v[80:95]
  v_mfma_f32_32x32x16_bf16 v[96:111], a[92:95], a[56:59], v[96:111]
  buffer_load_dwordx4 a[36:39], v229, s[36:39], s16 offen offset:0 sc1
  v_mfma_f32_32x32x16_bf16 v[64:79], a[88:91], a[56:59], v[64:79]
  s_waitcnt vmcnt(14)
  v_mfma_f32_32x32x16_bf16 v[112:127], a[100:103], a[4:7], v[112:127]
  buffer_load_dwordx4 a[40:43], v228, s[36:39], s16 offen offset:1024 sc1
  v_mfma_f32_32x32x16_bf16 v[80:95], a[96:99], a[4:7], v[80:95]
  v_mfma_f32_32x32x16_bf16 v[96:111], a[100:103], a[0:3], v[96:111]
  buffer_load_dwordx4 a[44:47], v229, s[36:39], s16 offen offset:1024 sc1
  v_mfma_f32_32x32x16_bf16 v[64:79], a[96:99], a[0:3], v[64:79]
  s_waitcnt vmcnt(14)
  v_mfma_f32_32x32x16_bf16 v[112:127], a[108:111], a[12:15], v[112:127]
  buffer_load_dwordx4 a[48:51], v228, s[36:39], s16 offen offset:2048 sc1
  v_mfma_f32_32x32x16_bf16 v[80:95], a[104:107], a[12:15], v[80:95]
  v_mfma_f32_32x32x16_bf16 v[96:111], a[108:111], a[8:11], v[96:111]
  buffer_load_dwordx4 a[52:55], v229, s[36:39], s16 offen offset:2048 sc1
  v_mfma_f32_32x32x16_bf16 v[64:79], a[104:107], a[8:11], v[64:79]
  s_waitcnt vmcnt(8)
  v_mfma_f32_32x32x16_bf16 v[112:127], a[164:167], a[20:23], v[112:127]
  buffer_load_dwordx4 a[56:59], v228, s[36:39], s16 offen offset:3072 sc1
  v_mfma_f32_32x32x16_bf16 v[80:95], a[160:163], a[20:23], v[80:95]
  v_mfma_f32_32x32x16_bf16 v[96:111], a[164:167], a[16:19], v[96:111]
  buffer_load_dwordx4 a[60:63], v229, s[36:39], s16 offen offset:3072 sc1
  v_mfma_f32_32x32x16_bf16 v[64:79], a[160:163], a[16:19], v[64:79]
  s_waitcnt vmcnt(8)
  v_mfma_f32_32x32x16_bf16 v[112:127], a[172:175], a[28:31], v[112:127]
  s_waitcnt lgkmcnt(0)
  s_cmp_eq_u64 s[60:61], s[74:75]
  s_cselect_b64 s[62:63], s[62:63], 0
  s_cmp_eq_u64 s[62:63], s[74:75]
  s_cselect_b64 s[64:65], s[64:65], 0
  s_cmp_eq_u64 s[64:65], s[74:75]
  s_cselect_b64 s[66:67], s[66:67], 0
  s_cmp_eq_u64 s[66:67], s[74:75]
  s_cbranch_scc0 L_poll5
L_poll5_back:
  v_mfma_f32_32x32x16_bf16 v[80:95], a[168:171], a[28:31], v[80:95]
  s_movk_i32 s16, 12288
  buffer_load_dwordx4 a[0:3], v228, s[36:39], s16 offen offset:0 sc1
  v_mfma_f32_32x32x16_bf16 v[96:111], a[172:175], a[24:27], v[96:111]
  buffer_load_dwordx4 a[4:7], v229, s[36:39], s16 offen offset:0 sc1
  v_mfma_f32_32x32x16_bf16 v[64:79], a[168:171], a[24:27], v[64:79]
  s_waitcnt vmcnt(8)
  v_mfma_f32_32x32x16_bf16 v[112:127], a[180:183], a[36:39], v[112:127]
  buffer_load_dwordx4 a[8:11], v228, s[36:39], s16 offen offset:1024 sc1
  buffer_load_dwordx4 a[12:15], v229, s[36:39], s16 offen offset:1024 sc1
  v_mfma_f32_32x32x16_bf16 v[80:95], a[176:179], a[36:39], v[80:95]
  s_load_dwordx2 s[60:61], s[20:21], 0x40000 glc
  v_mfma_f32_32x32x16_bf16 v[96:111], a[180:183], a[32:35], v[96:111]
  s_load_dwordx2 s[62:63], s[20:21], 0x40080 glc
  s_load_dwordx2 s[64:65], s[20:21], 0x40100 glc
  s_load_dwordx2 s[66:67], s[20:21], 0x40180 glc
  v_lshlrev_b32 v12, 8, v3
  v_and_b32 v13, 15, v1
  v_mfma_f32_32x32x16_bf16 v[64:79], a[176:179], a[32:35], v[64:79]
  v_xor_b32 v13, v13, v2
  v_lshl_add_u32 v12, v13, 4, v12
  v_add_u32 v10, s5, v12
  v_add_u32 v11, s4, v12
  s_waitcnt vmcnt(8)
  v_mfma_f32_32x32x16_bf16 v[112:127], a[188:191], a[44:47], v[112:127]
  buffer_load_dwordx4 a[16:19], v228, s[36:39], s16 offen offset:2048 sc1
  v_mfma_f32_32x32x16_bf16 v[80:95], a[184:187], a[44:47], v[80:95]
  buffer_load_dwordx4 a[20:23], v229, s[36:39], s16 offen offset:2048 sc1
  v_mfma_f32_32x32x16_bf16 v[96:111], a[188:191], a[40:43], v[96:111]
  s_mul_i32 s76, s84, -2048
  s_add_u32 s76, s76, 14336
  s_mul_i32 s77, s84, 114688
  v_mfma_f32_32x32x16_bf16 v[64:79], a[184:187], a[40:43], v[64:79]
  s_lshl_b32 s78, s85, 12
  s_add_u32 s77, s77, s78
  v_lshrrev_b32 v14, 3, v1
  s_waitcnt vmcnt(8)
  v_mfma_f32_32x32x16_bf16 v[112:127], a[196:199], a[52:55], v[112:127]
  buffer_load_dwordx4 a[24:27], v228, s[36:39], s16 offen offset:3072 sc1
  buffer_load_dwordx4 a[28:31], v229, s[36:39], s16 offen offset:3072 sc1
  ds_read_b64_tr_b16 a[64:65], v220 offset:10240
  v_mfma_f32_32x32x16_bf16 v[80:95], a[192:195], a[52:55], v[80:95]
  ds_read_b64_tr_b16 a[66:67], v220 offset:11264
  ds_read_b64_tr_b16 a[68:69], v221 offset:10240
  ds_read_b64_tr_b16 a[70:71], v221 offset:11264
  ds_read_b64_tr_b16 a[72:73], v222 offset:0
  ds_read_b64_tr_b16 a[74:75], v222 offset:1024
  ds_read_b64_tr_b16 a[76:77], v223 offset:0
  ds_read_b64_tr_b16 a[78:79], v223 offset:1024
  ds_read_b64_tr_b16 a[80:81], v222 offset:2048
  ds_read_b64_tr_b16 a[82:83], v222 offset:3072
  ds_read_b64_tr_b16 a[84:85], v223 offset:2048
  v_mfma_f32_32x32x16_bf16 v[96:111], a[196:199], a[48:51], v[96:111]
  ds_read_b64_tr_b16 a[86:87], v223 offset:3072
  ds_read_b64_tr_b16 a[88:89], v222 offset:4096
  ds_read_b64_tr_b16 a[90:91], v222 offset:5120
  ds_read_b64_tr_b16 a[92:93], v223 offset:4096
  ds_read_b64_tr_b16 a[94:95], v223 offset:5120
  ds_read_b64_tr_b16 a[96:97], v224 offset:28672
  ds_read_b64_tr_b16 a[98:99], v224 offset:29696
  ds_read_b64_tr_b16 a[100:101], v225 offset:28672
  ds_read_b64_tr_b16 a[102:103], v225 offset:29696
  ds_read_b64_tr_b16 a[104:105], v224 offset:30720
  v_mfma_f32_32x32x16_bf16 v[64:79], a[192:195], a[48:51], v[64:79]
  ds_read_b64_tr_b16 a[106:107], v226 offset:31744
  ds_read_b64_tr_b16 a[108:109], v225 offset:30720
  ds_read_b64_tr_b16 a[110:111], v227 offset:31744
  v_lshlrev_b32 v13, 8, v14
  v_add_u32 v13, s77, v13
  v_and_b32 v12, 7, v1
  v_lshlrev_b32 v12, 1, v12
  v_xor_b32 v12, v12, v14
  v_lshl_add_u32 v16, v12, 4, v13
  v_xor_b32 v17, 16, v16
  s_waitcnt vmcnt(8)
  v_mfma_f32_32x32x16_bf16 v[112:127], a[204:207], a[60:63], v[112:127]
  s_waitcnt lgkmcnt(0)
  s_cmp_eq_u64 s[60:61], s[74:75]
  s_cselect_b64 s[62:63], s[62:63], 0
  s_cmp_eq_u64 s[62:63], s[74:75]
  s_cselect_b64 s[64:65], s[64:65], 0
  s_cmp_eq_u64 s[64:65], s[74:75]
  s_cselect_b64 s[66:67], s[66:67], 0
  s_cmp_eq_u64 s[66:67], s[74:75]
  s_cbranch_scc0 L_poll6
L_poll6_back:
  buffer_load_dword v8, v5, s[36:39], s12 offen sc1
  v_mfma_f32_32x32x16_bf16 v[80:95], a[200:203], a[60:63], v[80:95]
  buffer_load_dword v9, v5, s[36:39], s12 offen offset:32 sc1
  s_mul_i32 s16, s56, -20480
  s_add_u32 s16, s16, 114688
  s_lshr_b32 s89, s89, 2
  s_add_u32 s16, s16, s89
  v_mfma_f32_32x32x16_bf16 v[96:111], a[204:207], a[56:59], v[96:111]
  s_lshl_b32 s89, s89, 1
  buffer_load_dwordx4 a[32:35], v228, s[36:39], s16 offen offset:0 sc1
  buffer_load_dwordx4 a[36:39], v229, s[36:39], s16 offen offset:0 sc1
  v_mfma_f32_32x32x16_bf16 v[64:79], a[200:203], a[56:59], v[64:79]
  v_xor_b32 v18, 128, v16
  v_xor_b32 v19, 128, v17
  v_add_u32 v20, s76, v16
  v_add_u32 v21, s76, v17
  v_add_u32 v22, s76, v18
  v_add_u32 v23, s76, v19
  s_waitcnt vmcnt(10)
  v_mfma_f32_32x32x16_bf16 v[112:127], a[68:71], a[4:7], v[112:127]
  buffer_load_dwordx4 a[40:43], v228, s[36:39], s16 offen offset:1024 sc1
  v_mfma_f32_32x32x16_bf16 v[80:95], a[64:67], a[4:7], v[80:95]
  buffer_load_dwordx4 a[44:47], v229, s[36:39], s16 offen offset:1024 sc1
  v_mfma_f32_32x32x16_bf16 v[96:111], a[68:71], a[0:3], v[96:111]
  v_add_u32 v24, s76, v20
  v_add_u32 v25, s76, v21
  v_add_u32 v26, s76, v22
  v_mfma_f32_32x32x16_bf16 v[64:79], a[64:67], a[0:3], v[64:79]
  v_add_u32 v27, s76, v23
  v_add_u32 v28, s76, v24
  v_add_u32 v29, s76, v25
  v_add_u32 v30, s76, v26
  s_waitcnt vmcnt(10)
  v_mfma_f32_32x32x16_bf16 v[112:127], a[76:79], a[12:15], v[112:127]
  buffer_load_dwordx4 a[48:51], v228, s[36:39], s16 offen offset:2048 sc1
  v_mfma_f32_32x32x16_bf16 v[80:95], a[72:75], a[12:15], v[80:95]
  buffer_load_dwordx4 a[52:55], v229, s[36:39], s16 offen offset:2048 sc1
  v_mfma_f32_32x32x16_bf16 v[96:111], a[76:79], a[8:11], v[96:111]
  v_add_u32 v31, s76, v27
  s_mov_b32 s52, s22
  s_and_b32 s53, s23, 0xffff
  v_mfma_f32_32x32x16_bf16 v[64:79], a[72:75], a[8:11], v[64:79]
  s_mov_b32 s54, 1835008
  s_mov_b32 s55, 0x20000
  s_lshl2_add_u32 s76, s86, s56
  s_waitcnt vmcnt(10)
  v_mfma_f32_32x32x16_bf16 v[112:127], a[84:87], a[20:23], v[112:127]
  buffer_load_dwordx4 a[56:59], v228, s[36:39], s16 offen offset:3072 sc1
  v_mfma_f32_32x32x16_bf16 v[80:95], a[80:83], a[20:23], v[80:95]
  buffer_load_dwordx4 a[60:63], v229, s[36:39], s16 offen offset:3072 sc1
  v_mfma_f32_32x32x16_bf16 v[96:111], a[84:87], a[16:19], v[96:111]
  s_mul_i32 s76, s76, 14336
  s_lshl_b32 s77, s87, 7
  s_add_u32 s76, s76, s77
  v_mfma_f32_32x32x16_bf16 v[64:79], a[80:83], a[16:19], v[64:79]
  s_add_u32 s77, s76, 7168
  v_mul_u32_u24 v14, 896, v14
  v_and_b32 v12, 7, v1
  v_lshl_add_u32 v14, v12, 4, v14
  s_waitcnt vmcnt(10)
  v_mfma_f32_32x32x16_bf16 v[112:127], a[92:95], a[28:31], v[112:127]
  s_add_u32 s16, s16, 4096
  s_sub_u32 s16, s16, s89
  buffer_load_dwordx4 a[0:3], v228, s[36:39], s16 offen offset:0 sc1
  buffer_load_dwordx4 a[4:7], v229, s[36:39], s16 offen offset:0 sc1
  v_mfma_f32_32x32x16_bf16 v[80:95], a[88:91], a[28:31], v[80:95]
  ds_read_b64_tr_b16 a[160:161], v224 offset:32256
  ds_read_b64_tr_b16 a[162:163], v224 offset:33280
  ds_read_b64_tr_b16 a[164:165], v225 offset:32256
  ds_read_b64_tr_b16 a[166:167], v225 offset:33280
  ds_read_b64_tr_b16 a[168:169], v224 offset:34304
  ds_read_b64_tr_b16 a[170:171], v226 offset:35328
  ds_read_b64_tr_b16 a[172:173], v225 offset:34304
  v_mfma_f32_32x32x16_bf16 v[96:111], a[92:95], a[24:27], v[96:111]
  ds_read_b64_tr_b16 a[174:175], v227 offset:35328
  ds_read_b64_tr_b16 a[176:177], v224 offset:0
  ds_read_b64_tr_b16 a[178:179], v224 offset:1024
  ds_read_b64_tr_b16 a[180:181], v225 offset:0
  ds_read_b64_tr_b16 a[182:183], v225 offset:1024
  ds_read_b64_tr_b16 a[184:185], v224 offset:2048
  ds_read_b64_tr_b16 a[186:187], v226 offset:3072
  ds_read_b64_tr_b16 a[188:189], v225 offset:2048
  ds_read_b64_tr_b16 a[190:191], v227 offset:3072
  v_mfma_f32_32x32x16_bf16 v[64:79], a[88:91], a[24:27], v[64:79]
  ds_read_b64_tr_b16 a[192:193], v224 offset:3584
  ds_read_b64_tr_b16 a[194:195], v224 offset:4608
  ds_read_b64_tr_b16 a[196:197], v225 offset:3584
  ds_read_b64_tr_b16 a[198:199], v225 offset:4608
  ds_read_b64_tr_b16 a[200:201], v224 offset:5632
  ds_read_b64_tr_b16 a[202:203], v226 offset:6656
  ds_read_b64_tr_b16 a[204:205], v225 offset:5632
  ds_read_b64_tr_b16 a[206:207], v227 offset:6656
  s_waitcnt vmcnt(8)
  v_mfma_f32_32x32x16_bf16 v[112:127], a[100:103], a[36:39], v[112:127]
  s_waitcnt lgkmcnt(0)
  buffer_load_dwordx4 a[8:11], v228, s[36:39], s16 offen offset:1024 sc1
  v_mfma_f32_32x32x16_bf16 v[80:95], a[96:99], a[36:39], v[80:95]
  v_mfma_f32_32x32x16_bf16 v[96:111], a[100:103], a[32:35], v[96:111]
  buffer_load_dwordx4 a[12:15], v229, s[36:39], s16 offen offset:1024 sc1
  v_mfma_f32_32x32x16_bf16 v[64:79], a[96:99], a[32:35], v[64:79]
  s_waitcnt vmcnt(8)
  v_mfma_f32_32x32x16_bf16 v[112:127], a[108:111], a[44:47], v[112:127]
  buffer_load_dwordx4 a[16:19], v228, s[36:39], s16 offen offset:2048 sc1
  v_mfma_f32_32x32x16_bf16 v[80:95], a[104:107], a[44:47], v[80:95]
  v_mfma_f32_32x32x16_bf16 v[96:111], a[108:111], a[40:43], v[96:111]
  buffer_load_dwordx4 a[20:23], v229, s[36:39], s16 offen offset:2048 sc1
  v_mfma_f32_32x32x16_bf16 v[64:79], a[104:107], a[40:43], v[64:79]
  s_waitcnt vmcnt(8)
  v_mfma_f32_32x32x16_bf16 v[112:127], a[164:167], a[52:55], v[112:127]
  buffer_load_dwordx4 a[24:27], v228, s[36:39], s16 offen offset:3072 sc1
  v_mfma_f32_32x32x16_bf16 v[80:95], a[160:163], a[52:55], v[80:95]
  v_mfma_f32_32x32x16_bf16 v[96:111], a[164:167], a[48:51], v[96:111]
  buffer_load_dwordx4 a[28:31], v229, s[36:39], s16 offen offset:3072 sc1
  v_mfma_f32_32x32x16_bf16 v[64:79], a[160:163], a[48:51], v[64:79]
  s_waitcnt vmcnt(8)
  v_mfma_f32_32x32x16_bf16 v[112:127], a[172:175], a[60:63], v[112:127]
  v_mfma_f32_32x32x16_bf16 v[80:95], a[168:171], a[60:63], v[80:95]
  v_mfma_f32_32x32x16_bf16 v[96:111], a[172:175], a[56:59], v[96:111]
  v_mfma_f32_32x32x16_bf16 v[64:79], a[168:171], a[56:59], v[64:79]
  s_waitcnt vmcnt(6)
  v_mfma_f32_32x32x16_bf16 v[112:127], a[180:183], a[4:7], v[112:127]
  s_waitcnt vmcnt(4)
  v_mfma_f32_32x32x16_bf16 v[112:127], a[188:191], a[12:15], v[112:127]
  s_waitcnt vmcnt(2)
  v_mfma_f32_32x32x16_bf16 v[112:127], a[196:199], a[20:23], v[112:127]
  s_waitcnt vmcnt(0)
  v_mfma_f32_32x32x16_bf16 v[112:127], a[204:207], a[28:31], v[112:127]
  v_mfma_f32_32x32x16_bf16 v[80:95], a[176:179], a[4:7], v[80:95]
  v_mfma_f32_32x32x16_bf16 v[80:95], a[184:187], a[12:15], v[80:95]
  v_xor_b32 v13, 128, v11
  v_mfma_f32_32x32x16_bf16 v[80:95], a[192:195], a[20:23], v[80:95]
  s_nop 7
  ds_write_b128 v13, v[112:115]
  v_xor_b32 v12, 160, v11
  v_mfma_f32_32x32x16_bf16 v[80:95], a[200:203], a[28:31], v[80:95]
  ds_write_b128 v12, v[116:119]
  v_xor_b32 v13, 192, v11
  ds_write_b128 v13, v[120:123]
  v_mfma_f32_32x32x16_bf16 v[96:111], a[180:183], a[0:3], v[96:111]
  v_xor_b32 v12, 224, v11
  ds_write_b128 v12, v[124:127]
  v_mfma_f32_32x32x16_bf16 v[96:111], a[188:191], a[8:11], v[96:111]
  s_nop 4
  ds_write_b128 v11, v[80:83]
  v_mfma_f32_32x32x16_bf16 v[96:111], a[196:199], a[16:19], v[96:111]
  v_xor_b32 v12, 32, v11
  ds_write_b128 v12, v[84:87]
  v_mfma_f32_32x32x16_bf16 v[96:111], a[204:207], a[24:27], v[96:111]
  v_xor_b32 v13, 64, v11
  ds_write_b128 v13, v[88:91]
  v_mfma_f32_32x32x16_bf16 v[64:79], a[176:179], a[0:3], v[64:79]
  v_xor_b32 v12, 96, v11
  ds_write_b128 v12, v[92:95]
  v_mfma_f32_32x32x16_bf16 v[64:79], a[184:187], a[8:11], v[64:79]
  v_xor_b32 v13, 128, v10
  v_mfma_f32_32x32x16_bf16 v[64:79], a[192:195], a[16:19], v[64:79]
  s_nop 3
  ds_write_b128 v13, v[96:99]
  v_xor_b32 v12, 160, v10
  v_mfma_f32_32x32x16_bf16 v[64:79], a[200:203], a[24:27], v[64:79]
  ds_write_b128 v12, v[100:103]
  v_xor_b32 v13, 192, v10
  ds_write_b128 v13, v[104:107]
  v_xor_b32 v12, 224, v10
  ds_write_b128 v12, v[108:111]
  s_nop 6
  ds_write_b128 v10, v[64:67]
  v_xor_b32 v12, 32, v10
  ds_write_b128 v12, v[68:71]
  v_xor_b32 v13, 64, v10
  ds_write_b128 v13, v[72:75]
  v_xor_b32 v12, 96, v10
  ds_write_b128 v12, v[76:79]
  s_waitcnt lgkmcnt(0)
  s_barrier
  ds_read_b128 v[64:67], v16 offset:0
  ds_read_b128 v[68:71], v17 offset:0
  ds_read_b128 v[72:75], v20 offset:0
  ds_read_b128 v[76:79], v21 offset:0
  ds_read_b128 v[80:83], v24 offset:0
  ds_read_b128 v[84:87], v25 offset:0
  ds_read_b128 v[88:91], v28 offset:0
  ds_read_b128 v[92:95], v29 offset:0
  ds_read_b128 v[96:99], v18 offset:2048
  ds_read_b128 v[100:103], v19 offset:2048
  ds_read_b128 v[104:107], v22 offset:2048
  ds_read_b128 v[108:111], v23 offset:2048
  ds_read_b128 v[112:115], v26 offset:2048
  ds_read_b128 v[116:119], v27 offset:2048
  ds_read_b128 v[120:123], v30 offset:2048
  ds_read_b128 v[124:127], v31 offset:2048
  s_waitcnt lgkmcnt(13)
  v_pk_add_f32 v[64:65], v[64:65], v[72:73]
  v_pk_add_f32 v[66:67], v[66:67], v[74:75]
  s_waitcnt lgkmcnt(12)
  v_pk_add_f32 v[68:69], v[68:69], v[76:77]
  v_pk_add_f32 v[70:71], v[70:71], v[78:79]
  s_waitcnt lgkmcnt(9)
  v_pk_add_f32 v[80:81], v[80:81], v[88:89]
  v_pk_add_f32 v[82:83], v[82:83], v[90:91]
  s_waitcnt lgkmcnt(8)
  v_pk_add_f32 v[84:85], v[84:85], v[92:93]
  v_pk_add_f32 v[86:87], v[86:87], v[94:95]
  v_pk_add_f32 v[64:65], v[64:65], v[80:81]
  v_pk_add_f32 v[66:67], v[66:67], v[82:83]
  v_pk_add_f32 v[68:69], v[68:69], v[84:85]
  v_pk_add_f32 v[70:71], v[70:71], v[86:87]
  v_pk_mul_f32 v[64:65], v[64:65], v[8:9] op_sel:[0,0] op_sel_hi:[1,0]
  v_pk_mul_f32 v[66:67], v[66:67], v[8:9] op_sel:[0,0] op_sel_hi:[1,0]
  v_pk_mul_f32 v[68:69], v[68:69], v[8:9] op_sel:[0,0] op_sel_hi:[1,0]
  v_pk_mul_f32 v[70:71], v[70:71], v[8:9] op_sel:[0,0] op_sel_hi:[1,0]
  v_cvt_pk_bf16_f32 v72, v64, v65
  v_cvt_pk_bf16_f32 v73, v66, v67
  v_cvt_pk_bf16_f32 v74, v68, v69
  v_cvt_pk_bf16_f32 v75, v70, v71
  buffer_store_dwordx4 v[72:75], v14, s[52:55], s76 offen sc0 sc1
  s_waitcnt lgkmcnt(5)
  v_pk_add_f32 v[96:97], v[96:97], v[104:105]
  v_pk_add_f32 v[98:99], v[98:99], v[106:107]
  s_waitcnt lgkmcnt(4)
  v_pk_add_f32 v[100:101], v[100:101], v[108:109]
  v_pk_add_f32 v[102:103], v[102:103], v[110:111]
  s_waitcnt lgkmcnt(1)
  v_pk_add_f32 v[112:113], v[112:113], v[120:121]
  v_pk_add_f32 v[114:115], v[114:115], v[122:123]
  s_waitcnt lgkmcnt(0)
  v_pk_add_f32 v[116:117], v[116:117], v[124:125]
  v_pk_add_f32 v[118:119], v[118:119], v[126:127]
  v_pk_add_f32 v[96:97], v[96:97], v[112:113]
  v_pk_add_f32 v[98:99], v[98:99], v[114:115]
  v_pk_add_f32 v[100:101], v[100:101], v[116:117]
  v_pk_add_f32 v[102:103], v[102:103], v[118:119]
  v_pk_mul_f32 v[96:97], v[96:97], v[8:9] op_sel:[0,1] op_sel_hi:[1,1]
  v_pk_mul_f32 v[98:99], v[98:99], v[8:9] op_sel:[0,1] op_sel_hi:[1,1]
  v_pk_mul_f32 v[100:101], v[100:101], v[8:9] op_sel:[0,1] op_sel_hi:[1,1]
  v_pk_mul_f32 v[102:103], v[102:103], v[8:9] op_sel:[0,1] op_sel_hi:[1,1]
  v_cvt_pk_bf16_f32 v104, v96, v97
  v_cvt_pk_bf16_f32 v105, v98, v99
  v_cvt_pk_bf16_f32 v106, v100, v101
  v_cvt_pk_bf16_f32 v107, v102, v103
  buffer_store_dwordx4 v[104:107], v14, s[52:55], s77 offen sc0 sc1
  s_endpgm

L_mlp:
  s_mov_b32 s52, s6
  s_and_b32 s53, s7, 0xffff
  s_mov_b32 s54, 1204224
  s_mov_b32 s55, 0x20000
  s_mov_b32 s48, s8
  s_and_b32 s49, s9, 0xffff
  s_mov_b32 s50, 25088
  s_mov_b32 s51, 0x20000
  v_cmp_eq_u32 s[92:93], 1, v2
  v_mov_b32 v13, 0xff800000
  s_nop 0
  v_cndmask_b32 v11, 0, v13, s[92:93]
  v_bfe_u32 v13, v1, 4, 1
  v_lshlrev_b32 v13, 2, v13
  v_and_or_b32 v13, v1, 3, v13
  v_min_u32 v13, 6, v13
  v_bfe_u32 v14, v1, 2, 2
  v_lshl_add_u32 v14, v2, 2, v14
  v_mul_u32_u24 v14, 56, v14
  v_lshl_add_u32 v12, v13, 3, v14
  s_mul_i32 s76, s85, 1568
  s_add_u32 s76, s76, 57344
  v_add_u32 v12, s76, v12
  s_mul_i32 s76, s58, 448
  s_add_u32 s77, s76, 64
  s_and_b32 s77, s77, 0xffffff80
  s_lshl_b32 s78, s85, 6
  s_add_u32 s78, s78, s77
  s_bitcmp0_b32 s58, 0
  s_cselect_b32 s15, 384, 0
  s_add_u32 s15, s15, s76
  s_lshl_b32 s13, s78, 5
  v_lshlrev_b32 v13, 1, v3
  v_add_u32 v24, s78, v13
  v_add_u32 v25, s78, v13
  v_mov_b32 v26, 0
  v_mov_b32 v27, 0
  v_mov_b32 v14, 0x3f3504f3
  v_mov_b32 v15, 0x3f3504f3
  v_cmp_eq_u32 vcc, 0, v2
  v_mov_b32 v13, 0x3f80
  v_mov_b32 v29, 0
  v_cndmask_b32 v28, 0, v13, vcc
  v_mov_b32 v30, 0
  v_mov_b32 v31, 0
  s_lshl2_add_u32 s76, s2, s56
  s_and_b32 s76, s76, 511
  s_mul_i32 s78, s76, 3200
  s_mul_i32 s79, s76, 896
  s_lshl2_add_u32 s80, s57, s56
  s_mul_i32 s80, s80, 25088
  s_mul_i32 s81, s58, 448
  s_and_b32 s81, s81, 0xffffff80
  s_add_u32 s80, s80, s81
  v_lshlrev_b32 v32, 7, v1
  v_bfrev_b32 v13, 1
  v_cmp_gt_u32 vcc, 25, v1
  v_add_u32 v128, s78, v32
  v_add_u32 v129, s79, v32
  v_cndmask_b32 v128, v13, v128, vcc
  v_cmp_gt_u32 vcc, 7, v1
  v_lshrrev_b32 v130, 2, v1
  v_mul_u32_u24 v130, 3584, v130
  v_cndmask_b32 v129, v13, v129, vcc
  v_and_b32 v32, 0x180, v32
  v_cmp_gt_u32 vcc, 28, v1
  v_add3_u32 v130, v130, v32, s80
  s_nop 0
  v_cndmask_b32 v130, v13, v130, vcc
  s_mul_i32 s79, s58, 112
  v_lshrrev_b32 v35, 3, v1
  v_mul_u32_u24 v35, 2688, v35
  v_add_u32 v35, s79, v35
  v_lshrrev_b32 v36, 2, v1
  v_and_b32 v36, 4, v36
  v_xor_b32 v36, v36, v1
  v_and_b32 v36, 7, v36
  v_min_u32 v36, 6, v36
  v_lshl_add_u32 v33, v36, 4, v35
  v_add_u32 v34, 20480, v33
  s_lshl2_add_u32 s76, s57, s56
  s_mul_i32 s76, s76, 28672
  s_mul_i32 s76, s76, 1344
  s_mul_i32 s101, s56, 43008
  s_sub_u32 s101, s101, s76
  v_min_u32 v13, 55, v1
  v_lshrrev_b32 v32, 3, v13
  v_and_b32 v13, 7, v13
  v_lshl_add_u32 v36, v32, 5, v13
  s_lshl_b32 s76, s56, 3
  v_add_u32 v36, s76, v36
  s_lshl_b32 s76, s59, 7
  v_lshlrev_b32 v13, 2, v36
  v_add_u32 v13, s76, v13
  v_subrev_u32 v32, 896, v13
  v_min_u32 v35, v13, v32
  v_and_b32 v13, 1, v36
  v_lshlrev_b32 v13, 6, v13
  v_xor_b32 v13, 112, v13
  v_lshl_add_u32 v36, v36, 8, v13
  s_add_u32 s76, s97, 98304
  v_lshlrev_b32 v37, 7, v3
  v_add_u32 v37, s76, v37
  v_bfe_u32 v38, v3, 1, 3
  v_xor_b32 v38, v38, v2
  v_xor_b32 v39, 0, v38
  v_lshl_add_u32 v40, v39, 4, v37
  v_xor_b32 v44, 4096, v40
  v_xor_b32 v39, 2, v38
  v_lshl_add_u32 v41, v39, 4, v37
  v_xor_b32 v45, 4096, v41
  v_xor_b32 v39, 4, v38
  v_lshl_add_u32 v42, v39, 4, v37
  v_xor_b32 v46, 4096, v42
  v_xor_b32 v39, 6, v38
  v_lshl_add_u32 v43, v39, 4, v37
  v_xor_b32 v47, 4096, v43
  v_bfe_u32 v38, v1, 4, 1
  v_lshlrev_b32 v38, 2, v38
  v_and_or_b32 v38, v1, 3, v38
  s_mul_i32 s76, s85, 64
  v_lshlrev_b32 v38, 3, v38
  v_add_u32 v38, s76, v38
  v_and_b32 v39, 8, v1
  v_lshlrev_b32 v39, 3, v39
  v_xor_b32 v38, v38, v39
  v_bfe_u32 v39, v1, 2, 2
  v_lshl_add_u32 v39, v2, 3, v39
  v_lshl_add_u32 v37, v39, 7, v38
  v_bfe_u32 v39, v1, 4, 1
  v_lshlrev_b32 v39, 2, v39
  v_and_or_b32 v39, v1, 3, v39
  s_mul_i32 s76, s85, 56
  v_cmp_eq_u32 vcc, 7, v39
  v_lshlrev_b32 v39, 3, v39
  v_add_u32 v39, s76, v39
  v_mov_b32 v48, 112
  v_cndmask_b32 v39, v39, v48, vcc
  v_and_b32 v48, 8, v1
  v_lshlrev_b32 v48, 3, v48
  v_xor_b32 v39, v39, v48
  v_bfe_u32 v48, v1, 2, 2
  v_lshl_add_u32 v48, v2, 3, v48
  v_lshl_add_u32 v38, v48, 7, v39
  v_add_u32 v38, 57344, v38
  s_lshl2_add_u32 s76, s57, s56
  s_xor_b32 s77, s76, 1
  s_mul_i32 s76, s76, 147456
  s_mul_i32 s77, s77, 147456
  v_add_u32 v39, s76, v4
  v_add_u32 v48, s77, v4
  v_lshlrev_b32 v49, 3, v1
  v_cmp_gt_u32 vcc, 16, v1
  v_bfrev_b32 v52, 1
  s_nop 0
  v_cndmask_b32 v52, v52, v49, vcc
  v_mov_b32 v49, 0
  s_lshl1_add_u32 s100, s57, s84
  s_lshl3_add_u32 s100, s100, s58
  s_lshl1_add_u32 s100, s100, s85
  s_lshl_b32 s100, s100, 7
  s_min_u32 s76, s87, 6
  s_lshl_b32 s76, s76, 7
  s_cmp_eq_u32 s87, 7
  s_cselect_b32 s76, 0x40000000, s76
  v_lshrrev_b32 v57, 3, v1
  v_mul_u32_u24 v57, 896, v57
  v_add_u32 v57, s76, v57
  v_lshrrev_b32 v58, 2, v1
  v_and_b32 v58, 4, v58
  v_xor_b32 v58, v58, v1
  v_and_b32 v58, 7, v58
  v_lshl_add_u32 v53, v58, 4, v57
  v_add_u32 v54, 6144, v53
  v_add_u32 v55, 12288, v53
  v_add_u32 v56, 18432, v53
  v_bfe_u32 v57, v1, 4, 1
  v_lshlrev_b32 v57, 2, v57
  v_and_or_b32 v57, v1, 3, v57
  v_lshlrev_b32 v57, 3, v57
  v_and_b32 v58, 8, v1
  v_lshlrev_b32 v58, 3, v58
  v_xor_b32 v57, v57, v58
  v_bfe_u32 v58, v1, 2, 2
  v_lshl_add_u32 v57, v58, 7, v57
  s_mul_i32 s4, s56, 12288
  s_add_u32 s4, s4, 114688
  s_mul_i32 s5, s56, 14336
  s_mul_i32 s6, s56, 7168
  s_add_u32 s6, s6, 57344
  v_lshl_add_u32 v58, v2, 9, v57
  v_add_u32 v59, s4, v58
  v_add_u32 v61, s5, v58
  v_add_u32 v63, s6, v58
  v_add_u32 v217, s6, v57
  v_xor_b32 v60, 64, v59
  v_xor_b32 v62, 64, v61
  v_xor_b32 v216, 64, v63
  v_xor_b32 v218, 64, v217
  s_mul_i32 s7, s56, 401408
  s_mul_i32 s8, s56, 100352
  s_mul_i32 s76, s89, 229376
  s_add_u32 s18, s7, s76
  s_sub_u32 s19, s7, s76
  s_mul_i32 s76, s89, 50176
  s_sub_u32 s3, s8, s76
  s_add_u32 s8, s8, s76
  s_lshl_b32 s89, s89, 14
  s_mul_i32 s76, s86, 294912
  s_mul_i32 s77, s56, 28672
  s_add_u32 s76, s76, s77
  v_add_u32 v219, s76, v4
  v_add_u32 v220, 147456, v219
  s_lshl2_add_u32 s76, s86, s56
  s_lshl_b32 s76, s76, 2
  v_and_b32 v221, 3, v1
  v_add_u32 v221, s76, v221
  v_lshlrev_b32 v221, 7, v221
  s_lshl1_add_u32 s11, s58, s85
  s_lshl_b32 s76, s11, 12
  s_add_u32 s10, s76, 11534336
  s_lshl_b32 s11, s11, 11
  s_add_u32 s11, s11, 114688
  s_lshl4_add_u32 s14, s58, s57
  s_lshl2_add_u32 s14, s14, s56
  s_lshl_b32 s14, s14, 7
  s_add_u32 s14, s14, 12058496
  v_lshlrev_b32 v57, 7, v3
  v_add_u32 v57, s76, v57
  s_lshl2_add_u32 s76, s58, s56
  s_lshl_b32 s76, s76, 4
  s_add_u32 s77, s76, s57
  s_lshl_b32 s12, s77, 11
  s_add_u32 s12, s12, 10485760
  s_lshl_b32 s15, s77, 7
  v_and_b32 v58, 15, v1
  v_add_u32 v58, s76, v58
  v_lshlrev_b32 v58, 7, v58
  v_and_b32 v32, 7, v1
  v_lshlrev_b32 v32, 4, v32
  v_lshrrev_b32 v13, 4, v1
  v_lshl_add_u32 v222, v13, 2, v32
  v_and_b32 v13, 8, v1
  v_lshl_add_u32 v222, v13, 28, v222
  v_and_b32 v194, 15, v1
  v_lshlrev_b32 v194, 3, v194
  v_lshrrev_b32 v193, 4, v1
  s_add_u32 s76, s100, 12713984
  v_mov_b32 v192, s76
  s_add_u32 s76, s100, 13107200
  v_cmp_eq_u32 vcc, 1, v193
  v_mov_b32 v195, s76
  s_nop 0
  v_cndmask_b32 v192, v192, v195, vcc
  s_add_u32 s76, s100, 12845056
  v_cmp_eq_u32 vcc, 2, v193
  v_mov_b32 v195, s76
  s_nop 0
  v_cndmask_b32 v192, v192, v195, vcc
  s_add_u32 s76, s15, 12648448
  v_cmp_eq_u32 vcc, 3, v193
  v_mov_b32 v195, s76
  s_nop 0
  v_cndmask_b32 v192, v192, v195, vcc
  v_add_u32 v194, v192, v194
  v_mov_b32 v192, 0
  v_mov_b32 v193, 0
  s_add_u32 m0, s98, 8192
  s_nop 0
  buffer_load_dwordx4 v9, s[32:35], s68 offen offset:0 lds
  buffer_load_dwordx4 v10, s[32:35], s68 offen offset:1024 lds
  s_lshl_b32 s76, s56, 10
  s_add_u32 m0, s76, 57344
  s_mul_i32 s77, s58, 3136
  s_add_u32 s76, s76, s77
  buffer_load_dwordx4 v4, s[48:51], s76 offen lds
  global_load_ushort v24, v24, s[16:17] offset:0
  global_load_ushort v25, v25, s[16:17] offset:256
  global_load_dword v35, v35, s[20:21]
  buffer_store_dwordx2 v[192:193], v194, s[36:39], 0 offen sc1
  s_add_u32 m0, s97, 131072
  s_nop 0
  buffer_load_dwordx4 v5, s[28:31], s62 offen offset:0 lds
  buffer_load_dwordx4 v6, s[28:31], s62 offen offset:1024 lds
  buffer_load_dwordx4 v7, s[28:31], s62 offen offset:2048 lds
  buffer_load_dwordx4 v8, s[28:31], s62 offen offset:3072 lds
  s_add_u32 m0, s98, 16384
  s_nop 0
  buffer_load_dwordx4 v9, s[32:35], s69 offen offset:0 lds
  buffer_load_dwordx4 v10, s[32:35], s69 offen offset:1024 lds
  s_waitcnt vmcnt(17)
  s_barrier
  ds_read_b64_tr_b16 a[224:225], v37 offset:0
  s_add_u32 m0, s97, 147456
  ds_read_b64_tr_b16 a[226:227], v37 offset:512
  buffer_load_dwordx4 v5, s[28:31], s63 offen offset:0 lds
  ds_read_b128 a[0:3], v40 offset:0
  ds_read_b128 a[112:115], v44 offset:0
  ds_read_b64_tr_b16 a[228:229], v37 offset:2048
  ds_read_b64_tr_b16 a[230:231], v37 offset:2560
  ds_read_b128 a[4:7], v41 offset:0
  buffer_load_dwordx4 v6, s[28:31], s63 offen offset:1024 lds
  ds_read_b128 a[116:119], v45 offset:0
  ds_read_b64_tr_b16 a[232:233], v37 offset:4096
  ds_read_b64_tr_b16 a[234:235], v37 offset:4608
  ds_read_b128 a[8:11], v42 offset:0
  ds_read_b128 a[120:123], v46 offset:0
  buffer_load_dwordx4 v7, s[28:31], s63 offen offset:2048 lds
  ds_read_b64_tr_b16 a[236:237], v37 offset:6144
  ds_read_b64_tr_b16 a[238:239], v37 offset:6656
  ds_read_b128 a[12:15], v43 offset:0
  ds_read_b128 a[124:127], v47 offset:0
  buffer_load_dwordx4 v8, s[28:31], s63 offen offset:3072 lds
  s_waitcnt lgkmcnt(13)
  v_mfma_f32_32x32x16_bf16 v[64:79], a[224:227], a[0:3], 0
  s_add_u32 m0, s98, 24576
  s_nop 0
  buffer_load_dwordx4 v9, s[32:35], s70 offen offset:0 lds
  s_waitcnt lgkmcnt(12)
  v_mfma_f32_32x32x16_bf16 v[80:95], a[224:227], a[112:115], 0
  s_waitcnt lgkmcnt(9)
  v_mfma_f32_32x32x16_bf16 v[64:79], a[228:231], a[4:7], v[64:79]
  buffer_load_dwordx4 v10, s[32:35], s70 offen offset:1024 lds
  s_waitcnt lgkmcnt(8)
  v_mfma_f32_32x32x16_bf16 v[80:95], a[228:231], a[116:119], v[80:95]
  s_waitcnt vmcnt(17)
  s_waitcnt lgkmcnt(0)
  s_barrier
  v_mfma_f32_32x32x16_bf16 v[64:79], a[232:235], a[8:11], v[64:79]
  ds_read_b64_tr_b16 a[240:241], v37 offset:8192
  s_add_u32 m0, s97, 98304
  ds_read_b64_tr_b16 a[242:243], v37 offset:8704
  ds_read_b128 a[16:19], v40 offset:16384
  buffer_load_dwordx4 v5, s[28:31], s64 offen offset:0 lds
  ds_read_b128 a[128:131], v44 offset:16384
  ds_read_b64_tr_b16 a[244:245], v37 offset:10240
  ds_read_b64_tr_b16 a[246:247], v37 offset:10752
  ds_read_b128 a[20:23], v41 offset:16384
  ds_read_b128 a[132:135], v45 offset:16384
  v_mfma_f32_32x32x16_bf16 v[80:95], a[232:235], a[120:123], v[80:95]
  ds_read_b64_tr_b16 a[248:249], v37 offset:12288
  ds_read_b64_tr_b16 a[250:251], v37 offset:12800
  ds_read_b128 a[24:27], v42 offset:16384
  ds_read_b128 a[136:139], v46 offset:16384
  ds_read_b64_tr_b16 a[252:253], v37 offset:14336
  ds_read_b64_tr_b16 a[254:255], v37 offset:14848
  buffer_load_dwordx4 v6, s[28:31], s64 offen offset:1024 lds
  ds_read_b128 a[28:31], v43 offset:16384
  ds_read_b128 a[140:143], v47 offset:16384
  v_mfma_f32_32x32x16_bf16 v[64:79], a[236:239], a[12:15], v[64:79]
  buffer_load_dwordx4 v7, s[28:31], s64 offen offset:2048 lds
  v_mfma_f32_32x32x16_bf16 v[80:95], a[236:239], a[124:127], v[80:95]
  s_waitcnt lgkmcnt(13)
  v_mfma_f32_32x32x16_bf16 v[64:79], a[240:243], a[16:19], v[64:79]
  buffer_load_dwordx4 v8, s[28:31], s64 offen offset:3072 lds
  s_waitcnt lgkmcnt(12)
  v_mfma_f32_32x32x16_bf16 v[80:95], a[240:243], a[128:131], v[80:95]
  s_add_u32 m0, s98, 32768
  s_nop 0
  buffer_load_dwordx4 v9, s[32:35], s71 offen offset:0 lds
  s_waitcnt lgkmcnt(9)
  v_mfma_f32_32x32x16_bf16 v[64:79], a[244:247], a[20:23], v[64:79]
  buffer_load_dwordx4 v10, s[32:35], s71 offen offset:1024 lds
  s_waitcnt lgkmcnt(8)
  v_mfma_f32_32x32x16_bf16 v[80:95], a[244:247], a[132:135], v[80:95]
  s_waitcnt vmcnt(12)
  s_waitcnt lgkmcnt(0)
  s_barrier
  v_mfma_f32_32x32x16_bf16 v[64:79], a[248:251], a[24:27], v[64:79]
  ds_read_b64_tr_b16 a[224:225], v37 offset:16384
  s_add_u32 m0, s97, 114688
  ds_read_b64_tr_b16 a[226:227], v37 offset:16896
  ds_read_b128 a[32:35], v40 offset:32768
  buffer_load_dwordx4 v5, s[28:31], s65 offen offset:0 lds
  ds_read_b128 a[144:147], v44 offset:32768
  ds_read_b64_tr_b16 a[228:229], v37 offset:18432
  ds_read_b64_tr_b16 a[230:231], v37 offset:18944
  ds_read_b128 a[36:39], v41 offset:32768
  ds_read_b128 a[148:151], v45 offset:32768
  v_mfma_f32_32x32x16_bf16 v[80:95], a[248:251], a[136:139], v[80:95]
  ds_read_b64_tr_b16 a[232:233], v37 offset:20480
  ds_read_b64_tr_b16 a[234:235], v37 offset:20992
  ds_read_b128 a[40:43], v42 offset:32768
  ds_read_b128 a[152:155], v46 offset:32768
  ds_read_b64_tr_b16 a[236:237], v37 offset:22528
  ds_read_b64_tr_b16 a[238:239], v37 offset:23040
  buffer_load_dwordx4 v6, s[28:31], s65 offen offset:1024 lds
  ds_read_b128 a[44:47], v43 offset:32768
  ds_read_b128 a[156:159], v47 offset:32768
  v_mfma_f32_32x32x16_bf16 v[64:79], a[252:255], a[28:31], v[64:79]
  buffer_load_dwordx4 v7, s[28:31], s65 offen offset:2048 lds
  v_mfma_f32_32x32x16_bf16 v[80:95], a[252:255], a[140:143], v[80:95]
  s_waitcnt lgkmcnt(13)
  v_mfma_f32_32x32x16_bf16 v[64:79], a[224:227], a[32:35], v[64:79]
  buffer_load_dwordx4 v8, s[28:31], s65 offen offset:3072 lds
  s_waitcnt lgkmcnt(12)
  v_mfma_f32_32x32x16_bf16 v[80:95], a[224:227], a[144:147], v[80:95]
  s_add_u32 m0, s98, 40960
  s_nop 0
  buffer_load_dwordx4 v9, s[32:35], s72 offen offset:0 lds
  s_waitcnt lgkmcnt(9)
  v_mfma_f32_32x32x16_bf16 v[64:79], a[228:231], a[36:39], v[64:79]
  buffer_load_dwordx4 v10, s[32:35], s72 offen offset:1024 lds
  s_waitcnt lgkmcnt(8)
  v_mfma_f32_32x32x16_bf16 v[80:95], a[228:231], a[148:151], v[80:95]
  s_waitcnt vmcnt(12)
  s_waitcnt lgkmcnt(0)
  s_barrier
  v_mfma_f32_32x32x16_bf16 v[64:79], a[232:235], a[40:43], v[64:79]
  ds_read_b64_tr_b16 v[16:17], v12 offset:0
  s_add_u32 m0, s97, 131072
  ds_read_b64_tr_b16 v[18:19], v12 offset:448
  ds_read_b64_tr_b16 v[20:21], v12 offset:896
  ds_read_b64_tr_b16 v[22:23], v12 offset:1344
  buffer_load_dwordx4 v5, s[28:31], s66 offen offset:0 lds
  ds_read_b64_tr_b16 a[240:241], v37 offset:24576
  ds_read_b64_tr_b16 a[242:243], v37 offset:25088
  ds_read_b128 a[48:51], v40 offset:49152
  ds_read_b128 a[160:163], v44 offset:49152
  ds_read_b64_tr_b16 a[244:245], v37 offset:26624
  ds_read_b64_tr_b16 a[246:247], v37 offset:27136
  v_mfma_f32_32x32x16_bf16 v[80:95], a[232:235], a[152:155], v[80:95]
  ds_read_b128 a[52:55], v41 offset:49152
  ds_read_b128 a[164:167], v45 offset:49152
  ds_read_b64_tr_b16 a[248:249], v37 offset:28672
  ds_read_b64_tr_b16 a[250:251], v37 offset:29184
  ds_read_b128 a[56:59], v42 offset:49152
  ds_read_b128 a[168:171], v46 offset:49152
  ds_read_b64_tr_b16 a[252:253], v37 offset:30720
  buffer_load_dwordx4 v6, s[28:31], s66 offen offset:1024 lds
  ds_read_b64_tr_b16 a[254:255], v37 offset:31232
  ds_read_b128 a[60:63], v43 offset:49152
  ds_read_b128 a[172:175], v47 offset:49152
  v_mfma_f32_32x32x16_bf16 v[64:79], a[236:239], a[44:47], v[64:79]
  buffer_load_dwordx4 v7, s[28:31], s66 offen offset:2048 lds
  v_mfma_f32_32x32x16_bf16 v[80:95], a[236:239], a[156:159], v[80:95]
  s_waitcnt lgkmcnt(13)
  v_mfma_f32_32x32x16_bf16 v[64:79], a[240:243], a[48:51], v[64:79]
  buffer_load_dwordx4 v8, s[28:31], s66 offen offset:3072 lds
  s_waitcnt lgkmcnt(12)
  v_mfma_f32_32x32x16_bf16 v[80:95], a[240:243], a[160:163], v[80:95]
  s_add_u32 m0, s98, 49152
  s_nop 0
  buffer_load_dwordx4 v9, s[32:35], s73 offen offset:0 lds
  s_waitcnt lgkmcnt(9)
  v_mfma_f32_32x32x16_bf16 v[64:79], a[244:247], a[52:55], v[64:79]
  buffer_load_dwordx4 v10, s[32:35], s73 offen offset:1024 lds
  s_waitcnt lgkmcnt(8)
  v_mfma_f32_32x32x16_bf16 v[80:95], a[244:247], a[164:167], v[80:95]
  s_waitcnt vmcnt(12)
  s_waitcnt lgkmcnt(0)
  s_barrier
  v_mfma_f32_32x32x16_bf16 v[64:79], a[248:251], a[56:59], v[64:79]
  v_cndmask_b32 v22, v22, 0, s[92:93]
  s_mul_i32 s60, s60, 1344
  v_cndmask_b32 v23, v23, 0, s[92:93]
  ds_read_b64_tr_b16 a[224:225], v37 offset:32768
  s_add_u32 s60, s60, s101
  ds_read_b64_tr_b16 a[226:227], v37 offset:33280
  ds_read_b128 a[64:67], v40 offset:0
  ds_read_b128 a[176:179], v44 offset:0
  s_mul_i32 s61, s61, 1344
  ds_read_b64_tr_b16 a[228:229], v37 offset:34816
  ds_read_b64_tr_b16 a[230:231], v37 offset:35328
  s_add_u32 s61, s61, s101
  ds_read_b128 a[68:71], v41 offset:0
  v_mfma_f32_32x32x16_bf16 v[80:95], a[248:251], a[168:171], v[80:95]
  ds_read_b128 a[180:183], v45 offset:0
  s_mul_i32 s62, s62, 1344
  ds_read_b64_tr_b16 a[232:233], v37 offset:36864
  ds_read_b64_tr_b16 a[234:235], v37 offset:37376
  s_add_u32 s62, s62, s101
  ds_read_b128 a[72:75], v42 offset:0
  ds_read_b128 a[184:187], v46 offset:0
  s_mul_i32 s63, s63, 1344
  ds_read_b64_tr_b16 a[236:237], v37 offset:38912
  ds_read_b64_tr_b16 a[238:239], v37 offset:39424
  s_add_u32 s63, s63, s101
  ds_read_b128 a[76:79], v43 offset:0
  ds_read_b128 a[188:191], v47 offset:0
  v_mfma_f32_32x32x16_bf16 v[64:79], a[252:255], a[60:63], v[64:79]
  s_mul_i32 s64, s64, 1344
  s_add_u32 s64, s64, s101
  s_mul_i32 s65, s65, 1344
  s_add_u32 s65, s65, s101
  s_mul_i32 s66, s66, 1344
  v_mfma_f32_32x32x16_bf16 v[80:95], a[252:255], a[172:175], v[80:95]
  s_add_u32 s66, s66, s101
  s_add_u32 m0, s98, 57344
  s_nop 0
  buffer_load_dwordx4 v33, s[52:55], s60 offen offset:0 lds
  s_waitcnt lgkmcnt(13)
  v_mfma_f32_32x32x16_bf16 v[64:79], a[224:227], a[64:67], v[64:79]
  buffer_load_dwordx4 v34, s[52:55], s60 offen offset:1024 lds
  s_waitcnt lgkmcnt(12)
  v_mfma_f32_32x32x16_bf16 v[80:95], a[224:227], a[176:179], v[80:95]
  s_add_u32 m0, s98, 65536
  s_nop 0
  buffer_load_dwordx4 v33, s[52:55], s61 offen offset:0 lds
  s_waitcnt lgkmcnt(9)
  v_mfma_f32_32x32x16_bf16 v[64:79], a[228:231], a[68:71], v[64:79]
  buffer_load_dwordx4 v34, s[52:55], s61 offen offset:1024 lds
  s_waitcnt lgkmcnt(8)
  v_mfma_f32_32x32x16_bf16 v[80:95], a[228:231], a[180:183], v[80:95]
  s_waitcnt vmcnt(10)
  s_waitcnt lgkmcnt(0)
  s_barrier
  v_mfma_f32_32x32x16_bf16 v[64:79], a[232:235], a[72:75], v[64:79]
  ds_read_b64_tr_b16 a[240:241], v37 offset:40960
  s_add_u32 m0, s98, 73728
  ds_read_b64_tr_b16 a[242:243], v37 offset:41472
  ds_read_b128 a[80:83], v40 offset:16384
  ds_read_b128 a[192:195], v44 offset:16384
  buffer_load_dwordx4 v33, s[52:55], s62 offen offset:0 lds
  ds_read_b64_tr_b16 a[244:245], v37 offset:43008
  ds_read_b64_tr_b16 a[246:247], v37 offset:43520
  ds_read_b128 a[84:87], v41 offset:16384
  ds_read_b128 a[196:199], v45 offset:16384
  v_mfma_f32_32x32x16_bf16 v[80:95], a[232:235], a[184:187], v[80:95]
  ds_read_b64_tr_b16 a[248:249], v37 offset:45056
  ds_read_b64_tr_b16 a[250:251], v37 offset:45568
  ds_read_b128 a[88:91], v42 offset:16384
  ds_read_b128 a[200:203], v46 offset:16384
  ds_read_b64_tr_b16 a[252:253], v37 offset:47104
  ds_read_b64_tr_b16 a[254:255], v37 offset:47616
  ds_read_b128 a[92:95], v43 offset:16384
  ds_read_b128 a[204:207], v47 offset:16384
  v_mfma_f32_32x32x16_bf16 v[64:79], a[236:239], a[76:79], v[64:79]
  buffer_load_dwordx4 v34, s[52:55], s62 offen offset:1024 lds
  v_mfma_f32_32x32x16_bf16 v[80:95], a[236:239], a[188:191], v[80:95]
  s_waitcnt lgkmcnt(13)
  v_mfma_f32_32x32x16_bf16 v[64:79], a[240:243], a[80:83], v[64:79]
  s_add_u32 m0, s98, 81920
  s_nop 0
  buffer_load_dwordx4 v33, s[52:55], s63 offen offset:0 lds
  s_waitcnt lgkmcnt(12)
  v_mfma_f32_32x32x16_bf16 v[80:95], a[240:243], a[192:195], v[80:95]
  s_waitcnt lgkmcnt(9)
  v_mfma_f32_32x32x16_bf16 v[64:79], a[244:247], a[84:87], v[64:79]
  buffer_load_dwordx4 v34, s[52:55], s63 offen offset:1024 lds
  s_waitcnt lgkmcnt(8)
  v_mfma_f32_32x32x16_bf16 v[80:95], a[244:247], a[196:199], v[80:95]
  s_waitcnt vmcnt(8)
  s_waitcnt lgkmcnt(0)
  s_barrier
  v_mfma_f32_32x32x16_bf16 v[64:79], a[248:251], a[88:91], v[64:79]
  ds_read_b64_tr_b16 a[224:225], v37 offset:49152
  s_add_u32 m0, s98, 90112
  ds_read_b64_tr_b16 a[226:227], v37 offset:49664
  ds_read_b128 a[96:99], v40 offset:32768
  ds_read_b128 a[208:211], v44 offset:32768
  ds_read_b64_tr_b16 a[228:229], v37 offset:51200
  ds_read_b64_tr_b16 a[230:231], v37 offset:51712
  ds_read_b128 a[100:103], v41 offset:32768
  ds_read_b128 a[212:215], v45 offset:32768
  buffer_load_dwordx4 v33, s[52:55], s64 offen offset:0 lds
  v_mfma_f32_32x32x16_bf16 v[80:95], a[248:251], a[200:203], v[80:95]
  ds_read_b64_tr_b16 a[232:233], v37 offset:53248
  ds_read_b64_tr_b16 a[234:235], v37 offset:53760
  ds_read_b128 a[104:107], v42 offset:32768
  ds_read_b128 a[216:219], v46 offset:32768
  ds_read_b64_tr_b16 a[236:237], v37 offset:55296
  ds_read_b64_tr_b16 a[238:239], v37 offset:55808
  ds_read_b128 a[108:111], v43 offset:32768
  ds_read_b128 a[220:223], v47 offset:32768
  v_mfma_f32_32x32x16_bf16 v[64:79], a[252:255], a[92:95], v[64:79]
  v_mfma_f32_32x32x16_bf16 v[80:95], a[252:255], a[204:207], v[80:95]
  s_waitcnt lgkmcnt(13)
  v_mfma_f32_32x32x16_bf16 v[64:79], a[224:227], a[96:99], v[64:79]
  buffer_load_dwordx4 v34, s[52:55], s64 offen offset:1024 lds
  s_waitcnt lgkmcnt(12)
  v_mfma_f32_32x32x16_bf16 v[80:95], a[224:227], a[208:211], v[80:95]
  s_waitcnt lgkmcnt(9)
  v_mfma_f32_32x32x16_bf16 v[64:79], a[228:231], a[100:103], v[64:79]
  s_waitcnt lgkmcnt(8)
  v_mfma_f32_32x32x16_bf16 v[80:95], a[228:231], a[212:215], v[80:95]
  s_waitcnt lgkmcnt(5)
  v_mfma_f32_32x32x16_bf16 v[64:79], a[232:235], a[104:107], v[64:79]
  s_waitcnt lgkmcnt(4)
  v_mfma_f32_32x32x16_bf16 v[80:95], a[232:235], a[216:219], v[80:95]
  s_waitcnt lgkmcnt(1)
  v_mfma_f32_32x32x16_bf16 v[64:79], a[236:239], a[108:111], v[64:79]
  s_waitcnt lgkmcnt(0)
  v_mfma_f32_32x32x16_bf16 v[80:95], a[236:239], a[220:223], v[80:95]
  v_mfma_f32_32x32x16_bf16 v[64:79], v[24:27], v[28:31], v[64:79]
  v_mfma_f32_32x32x16_bf16 v[80:95], v[24:27], v[28:31], v[80:95]
  s_nop 10
  v_pk_mul_f32 v[192:193], v[64:65], s[90:91]
  s_add_u32 m0, s98, 98304
  v_pk_mul_f32 v[194:195], v[66:67], s[90:91]
  v_exp_f32 v192, v192
  v_exp_f32 v193, v193
  buffer_load_dwordx4 v33, s[52:55], s65 offen offset:0 lds
  v_exp_f32 v194, v194
  v_exp_f32 v195, v195
  v_pk_fma_f32 v[192:193], v[192:193], v[14:15], v[14:15]
  v_pk_fma_f32 v[194:195], v[194:195], v[14:15], v[14:15]
  v_pk_fma_f32 v[192:193], v[192:193], v[192:193], 0.5 op_sel_hi:[1,1,0]
  v_pk_fma_f32 v[194:195], v[194:195], v[194:195], 0.5 op_sel_hi:[1,1,0]
  v_rcp_f32 v192, v192
  v_rcp_f32 v193, v193
  v_rcp_f32 v194, v194
  v_rcp_f32 v195, v195
  v_pk_fma_f32 v[192:193], v[64:65], v[192:193], v[64:65] neg_lo:[1,0,0] neg_hi:[1,0,0]
  buffer_load_dwordx4 v34, s[52:55], s65 offen offset:1024 lds
  v_pk_fma_f32 v[194:195], v[66:67], v[194:195], v[66:67] neg_lo:[1,0,0] neg_hi:[1,0,0]
  v_cvt_pk_bf16_f32 v200, v192, v193
  v_cvt_pk_bf16_f32 v201, v194, v195
  v_pk_mul_f32 v[196:197], v[68:69], s[90:91]
  v_pk_mul_f32 v[198:199], v[70:71], s[90:91]
  v_exp_f32 v196, v196
  v_exp_f32 v197, v197
  v_exp_f32 v198, v198
  v_exp_f32 v199, v199
  v_pk_fma_f32 v[196:197], v[196:197], v[14:15], v[14:15]
  v_pk_fma_f32 v[198:199], v[198:199], v[14:15], v[14:15]
  v_pk_fma_f32 v[196:197], v[196:197], v[196:197], 0.5 op_sel_hi:[1,1,0]
  v_pk_fma_f32 v[198:199], v[198:199], v[198:199], 0.5 op_sel_hi:[1,1,0]
  v_rcp_f32 v196, v196
  s_add_u32 m0, s98, 106496
  v_rcp_f32 v197, v197
  v_rcp_f32 v198, v198
  buffer_load_dwordx4 v33, s[52:55], s66 offen offset:0 lds
  v_rcp_f32 v199, v199
  v_pk_fma_f32 v[196:197], v[68:69], v[196:197], v[68:69] neg_lo:[1,0,0] neg_hi:[1,0,0]
  v_pk_fma_f32 v[198:199], v[70:71], v[198:199], v[70:71] neg_lo:[1,0,0] neg_hi:[1,0,0]
  v_cvt_pk_bf16_f32 v202, v196, v197
  v_cvt_pk_bf16_f32 v203, v198, v199
  buffer_store_dwordx4 v[200:203], v39, s[36:39], s13 offen offset:0 sc1
  v_pk_mul_f32 v[192:193], v[72:73], s[90:91]
  v_pk_mul_f32 v[194:195], v[74:75], s[90:91]
  v_exp_f32 v192, v192
  v_exp_f32 v193, v193
  v_exp_f32 v194, v194
  v_exp_f32 v195, v195
  buffer_load_dwordx4 v34, s[52:55], s66 offen offset:1024 lds
  v_pk_fma_f32 v[192:193], v[192:193], v[14:15], v[14:15]
  v_pk_fma_f32 v[194:195], v[194:195], v[14:15], v[14:15]
  v_pk_fma_f32 v[192:193], v[192:193], v[192:193], 0.5 op_sel_hi:[1,1,0]
  v_pk_fma_f32 v[194:195], v[194:195], v[194:195], 0.5 op_sel_hi:[1,1,0]
  v_rcp_f32 v192, v192
  v_rcp_f32 v193, v193
  v_rcp_f32 v194, v194
  v_rcp_f32 v195, v195
  v_pk_fma_f32 v[192:193], v[72:73], v[192:193], v[72:73] neg_lo:[1,0,0] neg_hi:[1,0,0]
  v_pk_fma_f32 v[194:195], v[74:75], v[194:195], v[74:75] neg_lo:[1,0,0] neg_hi:[1,0,0]
  v_cvt_pk_bf16_f32 v204, v192, v193
  v_cvt_pk_bf16_f32 v205, v194, v195
  v_pk_mul_f32 v[196:197], v[76:77], s[90:91]
  global_load_dwordx2 v[50:51], v49, s[24:25] sc1
  v_pk_mul_f32 v[198:199], v[78:79], s[90:91]
  v_exp_f32 v196, v196
  v_exp_f32 v197, v197
  v_exp_f32 v198, v198
  v_exp_f32 v199, v199
  v_pk_fma_f32 v[196:197], v[196:197], v[14:15], v[14:15]
  v_pk_fma_f32 v[198:199], v[198:199], v[14:15], v[14:15]
  v_pk_fma_f32 v[196:197], v[196:197], v[196:197], 0.5 op_sel_hi:[1,1,0]
  v_pk_fma_f32 v[198:199], v[198:199], v[198:199], 0.5 op_sel_hi:[1,1,0]
  v_rcp_f32 v196, v196
  v_rcp_f32 v197, v197
  v_rcp_f32 v198, v198
  buffer_load_dword v130, v130, s[32:35], 0 offen
  v_rcp_f32 v199, v199
  v_pk_fma_f32 v[196:197], v[76:77], v[196:197], v[76:77] neg_lo:[1,0,0] neg_hi:[1,0,0]
  v_pk_fma_f32 v[198:199], v[78:79], v[198:199], v[78:79] neg_lo:[1,0,0] neg_hi:[1,0,0]
  v_cvt_pk_bf16_f32 v206, v196, v197
  v_cvt_pk_bf16_f32 v207, v198, v199
  buffer_store_dwordx4 v[204:207], v39, s[36:39], s13 offen offset:1024 sc1
  v_pk_mul_f32 v[192:193], v[80:81], s[90:91]
  v_pk_mul_f32 v[194:195], v[82:83], s[90:91]
  v_exp_f32 v192, v192
  v_exp_f32 v193, v193
  v_exp_f32 v194, v194
  buffer_load_dword v128, v128, s[40:43], 0 offen
  v_exp_f32 v195, v195
  v_pk_fma_f32 v[192:193], v[192:193], v[14:15], v[14:15]
  v_pk_fma_f32 v[194:195], v[194:195], v[14:15], v[14:15]
  v_pk_fma_f32 v[192:193], v[192:193], v[192:193], 0.5 op_sel_hi:[1,1,0]
  v_pk_fma_f32 v[194:195], v[194:195], v[194:195], 0.5 op_sel_hi:[1,1,0]
  v_rcp_f32 v192, v192
  v_rcp_f32 v193, v193
  v_rcp_f32 v194, v194
  v_rcp_f32 v195, v195
  v_pk_fma_f32 v[192:193], v[80:81], v[192:193], v[80:81] neg_lo:[1,0,0] neg_hi:[1,0,0]
  v_pk_fma_f32 v[194:195], v[82:83], v[194:195], v[82:83] neg_lo:[1,0,0] neg_hi:[1,0,0]
  v_cvt_pk_bf16_f32 v200, v192, v193
  v_cvt_pk_bf16_f32 v201, v194, v195
  v_pk_mul_f32 v[196:197], v[84:85], s[90:91]
  buffer_load_dword v129, v129, s[44:47], 0 offen
  v_pk_mul_f32 v[198:199], v[86:87], s[90:91]
  v_exp_f32 v196, v196
  v_exp_f32 v197, v197
  v_exp_f32 v198, v198
  v_exp_f32 v199, v199
  v_pk_fma_f32 v[196:197], v[196:197], v[14:15], v[14:15]
  v_pk_fma_f32 v[198:199], v[198:199], v[14:15], v[14:15]
  v_pk_fma_f32 v[196:197], v[196:197], v[196:197], 0.5 op_sel_hi:[1,1,0]
  v_pk_fma_f32 v[198:199], v[198:199], v[198:199], 0.5 op_sel_hi:[1,1,0]
  v_rcp_f32 v196, v196
  v_rcp_f32 v197, v197
  v_rcp_f32 v198, v198
  v_rcp_f32 v199, v199
  v_pk_fma_f32 v[196:197], v[84:85], v[196:197], v[84:85] neg_lo:[1,0,0] neg_hi:[1,0,0]
  v_pk_fma_f32 v[198:199], v[86:87], v[198:199], v[86:87] neg_lo:[1,0,0] neg_hi:[1,0,0]
  v_cvt_pk_bf16_f32 v202, v196, v197
  v_cvt_pk_bf16_f32 v203, v198, v199
  buffer_store_dwordx4 v[200:203], v48, s[36:39], s13 offen offset:0 sc1
  v_pk_mul_f32 v[192:193], v[88:89], s[90:91]
  v_pk_mul_f32 v[194:195], v[90:91], s[90:91]
  v_exp_f32 v192, v192
  v_exp_f32 v193, v193
  v_exp_f32 v194, v194
  v_exp_f32 v195, v195
  v_pk_fma_f32 v[192:193], v[192:193], v[14:15], v[14:15]
  v_pk_fma_f32 v[194:195], v[194:195], v[14:15], v[14:15]
  v_pk_fma_f32 v[192:193], v[192:193], v[192:193], 0.5 op_sel_hi:[1,1,0]
  v_pk_fma_f32 v[194:195], v[194:195], v[194:195], 0.5 op_sel_hi:[1,1,0]
  v_rcp_f32 v192, v192
  v_rcp_f32 v193, v193
  v_rcp_f32 v194, v194
  v_rcp_f32 v195, v195
  v_pk_fma_f32 v[192:193], v[88:89], v[192:193], v[88:89] neg_lo:[1,0,0] neg_hi:[1,0,0]
  v_pk_fma_f32 v[194:195], v[90:91], v[194:195], v[90:91] neg_lo:[1,0,0] neg_hi:[1,0,0]
  v_cvt_pk_bf16_f32 v204, v192, v193
  v_cvt_pk_bf16_f32 v205, v194, v195
  v_pk_mul_f32 v[196:197], v[92:93], s[90:91]
  v_pk_mul_f32 v[198:199], v[94:95], s[90:91]
  v_exp_f32 v196, v196
  v_exp_f32 v197, v197
  v_exp_f32 v198, v198
  v_exp_f32 v199, v199
  v_pk_fma_f32 v[196:197], v[196:197], v[14:15], v[14:15]
  v_pk_fma_f32 v[198:199], v[198:199], v[14:15], v[14:15]
  v_pk_fma_f32 v[196:197], v[196:197], v[196:197], 0.5 op_sel_hi:[1,1,0]
  v_pk_fma_f32 v[198:199], v[198:199], v[198:199], 0.5 op_sel_hi:[1,1,0]
  v_rcp_f32 v196, v196
  v_rcp_f32 v197, v197
  v_rcp_f32 v198, v198
  v_rcp_f32 v199, v199
  v_pk_fma_f32 v[196:197], v[92:93], v[196:197], v[92:93] neg_lo:[1,0,0] neg_hi:[1,0,0]
  v_pk_fma_f32 v[198:199], v[94:95], v[198:199], v[94:95] neg_lo:[1,0,0] neg_hi:[1,0,0]
  v_cvt_pk_bf16_f32 v206, v196, v197
  v_cvt_pk_bf16_f32 v207, v198, v199
  buffer_store_dwordx4 v[204:207], v48, s[36:39], s13 offen offset:1024 sc1
  v_and_b32 v192, 0xffff, v35
  v_mov_b32 v193, 0
  v_lshrrev_b32 v194, 16, v35
  v_mov_b32 v195, 0
  v_mov_b32 v24, v25
  s_nop 1
  v_mfma_f32_32x32x16_bf16 v[64:79], v[24:27], v[28:31], 0
  v_mfma_f32_32x32x16_bf16 v[80:95], v[24:27], v[28:31], 0
  s_waitcnt vmcnt(7)
  ds_write_b64 v36, v[192:193] offset:57344
  ds_write_b64 v36, v[194:195] offset:57472
  s_waitcnt lgkmcnt(0)
  s_barrier
  ds_read_b64_tr_b16 a[224:225], v38 offset:0
  ds_read_b64_tr_b16 a[226:227], v38 offset:512
  ds_read_b64_tr_b16 a[228:229], v38 offset:2048
  ds_read_b64_tr_b16 a[230:231], v38 offset:2560
  ds_read_b64_tr_b16 a[232:233], v38 offset:4096
  ds_read_b64_tr_b16 a[234:235], v38 offset:4608
  ds_read_b64_tr_b16 a[236:237], v38 offset:6144
  ds_read_b64_tr_b16 a[238:239], v38 offset:6656
  s_waitcnt lgkmcnt(4)
  v_mfma_f32_32x32x16_bf16 v[96:111], a[228:231], a[4:7], 0
  v_mfma_f32_32x32x16_bf16 v[112:127], a[228:231], a[116:119], 0
  ds_read_b64_tr_b16 a[240:241], v38 offset:8192
  ds_read_b64_tr_b16 a[242:243], v38 offset:8704
  v_mfma_f32_32x32x16_bf16 v[96:111], a[224:227], a[0:3], v[96:111]
  v_mfma_f32_32x32x16_bf16 v[112:127], a[224:227], a[112:115], v[112:127]
  ds_read_b64_tr_b16 a[244:245], v38 offset:10240
  ds_read_b64_tr_b16 a[246:247], v38 offset:10752
  s_waitcnt lgkmcnt(4)
  v_mfma_f32_32x32x16_bf16 v[96:111], a[236:239], a[12:15], v[96:111]
  v_mfma_f32_32x32x16_bf16 v[112:127], a[236:239], a[124:127], v[112:127]
  ds_read_b64_tr_b16 a[248:249], v38 offset:12288
  ds_read_b64_tr_b16 a[250:251], v38 offset:12800
  v_mfma_f32_32x32x16_bf16 v[96:111], a[232:235], a[8:11], v[96:111]
  v_mfma_f32_32x32x16_bf16 v[112:127], a[232:235], a[120:123], v[112:127]
  ds_read_b64_tr_b16 a[252:253], v38 offset:14336
  ds_read_b64_tr_b16 a[254:255], v38 offset:14848
  s_waitcnt lgkmcnt(4)
  v_mfma_f32_32x32x16_bf16 v[96:111], a[244:247], a[20:23], v[96:111]
  v_mfma_f32_32x32x16_bf16 v[112:127], a[244:247], a[132:135], v[112:127]
  ds_read_b64_tr_b16 a[224:225], v38 offset:16384
  ds_read_b64_tr_b16 a[226:227], v38 offset:16896
  v_mfma_f32_32x32x16_bf16 v[96:111], a[240:243], a[16:19], v[96:111]
  v_mfma_f32_32x32x16_bf16 v[112:127], a[240:243], a[128:131], v[112:127]
  ds_read_b64_tr_b16 a[228:229], v38 offset:18432
  ds_read_b64_tr_b16 a[230:231], v38 offset:18944
  s_waitcnt lgkmcnt(4)
  v_mfma_f32_32x32x16_bf16 v[96:111], a[252:255], a[28:31], v[96:111]
  v_mfma_f32_32x32x16_bf16 v[112:127], a[252:255], a[140:143], v[112:127]
  ds_read_b64_tr_b16 a[232:233], v38 offset:20480
  ds_read_b64_tr_b16 a[234:235], v38 offset:20992
  v_mfma_f32_32x32x16_bf16 v[96:111], a[248:251], a[24:27], v[96:111]
  v_mfma_f32_32x32x16_bf16 v[112:127], a[248:251], a[136:139], v[112:127]
  ds_read_b64_tr_b16 a[236:237], v38 offset:22528
  ds_read_b64_tr_b16 a[238:239], v38 offset:23040
  s_waitcnt lgkmcnt(4)
  v_mfma_f32_32x32x16_bf16 v[96:111], a[228:231], a[36:39], v[96:111]
  v_mfma_f32_32x32x16_bf16 v[112:127], a[228:231], a[148:151], v[112:127]
  ds_read_b64_tr_b16 a[240:241], v38 offset:24576
  ds_read_b64_tr_b16 a[242:243], v38 offset:25088
  v_mfma_f32_32x32x16_bf16 v[96:111], a[224:227], a[32:35], v[96:111]
  v_mfma_f32_32x32x16_bf16 v[112:127], a[224:227], a[144:147], v[112:127]
  v_add_u32 v9, 256, v9
  v_add_u32 v10, 256, v10
  ds_read_b64_tr_b16 a[244:245], v38 offset:26624
  ds_read_b64_tr_b16 a[246:247], v38 offset:27136
  s_waitcnt lgkmcnt(4)
  v_mfma_f32_32x32x16_bf16 v[96:111], a[236:239], a[44:47], v[96:111]
  s_add_u32 m0, s98, 0
  s_nop 0
  buffer_load_dwordx4 v9, s[32:35], s67 offen offset:0 lds
  v_mfma_f32_32x32x16_bf16 v[112:127], a[236:239], a[156:159], v[112:127]
  buffer_load_dwordx4 v10, s[32:35], s67 offen offset:1024 lds
  ds_read_b64_tr_b16 a[248:249], v38 offset:28672
  ds_read_b64_tr_b16 a[250:251], v38 offset:29184
  v_mfma_f32_32x32x16_bf16 v[96:111], a[232:235], a[40:43], v[96:111]
  v_mfma_f32_32x32x16_bf16 v[112:127], a[232:235], a[152:155], v[112:127]
  s_add_u32 m0, s98, 8192
  s_nop 0
  buffer_load_dwordx4 v9, s[32:35], s68 offen offset:0 lds
  ds_read_b64_tr_b16 a[252:253], v38 offset:30720
  ds_read_b64_tr_b16 a[254:255], v38 offset:31232
  s_waitcnt lgkmcnt(4)
  v_mfma_f32_32x32x16_bf16 v[96:111], a[244:247], a[52:55], v[96:111]
  v_mfma_f32_32x32x16_bf16 v[112:127], a[244:247], a[164:167], v[112:127]
  buffer_load_dwordx4 v10, s[32:35], s68 offen offset:1024 lds
  ds_read_b64_tr_b16 a[224:225], v38 offset:32768
  ds_read_b64_tr_b16 a[226:227], v38 offset:33280
  v_mfma_f32_32x32x16_bf16 v[96:111], a[240:243], a[48:51], v[96:111]
  s_add_u32 m0, s98, 16384
  s_nop 0
  buffer_load_dwordx4 v9, s[32:35], s69 offen offset:0 lds
  v_mfma_f32_32x32x16_bf16 v[112:127], a[240:243], a[160:163], v[112:127]
  ds_read_b64_tr_b16 a[228:229], v38 offset:34816
  ds_read_b64_tr_b16 a[230:231], v38 offset:35328
  s_waitcnt lgkmcnt(4)
  v_mfma_f32_32x32x16_bf16 v[96:111], a[252:255], a[60:63], v[96:111]
  buffer_load_dwordx4 v10, s[32:35], s69 offen offset:1024 lds
  v_mfma_f32_32x32x16_bf16 v[112:127], a[252:255], a[172:175], v[112:127]
  s_add_u32 m0, s98, 24576
  s_nop 0
  buffer_load_dwordx4 v9, s[32:35], s70 offen offset:0 lds
  ds_read_b64_tr_b16 a[232:233], v38 offset:36864
  ds_read_b64_tr_b16 a[234:235], v38 offset:37376
  v_mfma_f32_32x32x16_bf16 v[96:111], a[248:251], a[56:59], v[96:111]
  v_mfma_f32_32x32x16_bf16 v[112:127], a[248:251], a[168:171], v[112:127]
  buffer_load_dwordx4 v10, s[32:35], s70 offen offset:1024 lds
  ds_read_b64_tr_b16 a[236:237], v38 offset:38912
  ds_read_b64_tr_b16 a[238:239], v38 offset:39424
  s_waitcnt lgkmcnt(4)
  v_mfma_f32_32x32x16_bf16 v[96:111], a[228:231], a[68:71], v[96:111]
  s_add_u32 m0, s98, 32768
  v_mfma_f32_32x32x16_bf16 v[112:127], a[228:231], a[180:183], v[112:127]
  buffer_load_dwordx4 v9, s[32:35], s71 offen offset:0 lds
  ds_read_b64_tr_b16 a[240:241], v38 offset:40960
  ds_read_b64_tr_b16 a[242:243], v38 offset:41472
  v_mfma_f32_32x32x16_bf16 v[96:111], a[224:227], a[64:67], v[96:111]
  buffer_load_dwordx4 v10, s[32:35], s71 offen offset:1024 lds
  v_mfma_f32_32x32x16_bf16 v[112:127], a[224:227], a[176:179], v[112:127]
  s_add_u32 m0, s98, 40960
  ds_read_b64_tr_b16 a[244:245], v38 offset:43008
  ds_read_b64_tr_b16 a[246:247], v38 offset:43520
  s_waitcnt lgkmcnt(4)
  v_mfma_f32_32x32x16_bf16 v[96:111], a[236:239], a[76:79], v[96:111]
  buffer_load_dwordx4 v9, s[32:35], s72 offen offset:0 lds
  v_mfma_f32_32x32x16_bf16 v[112:127], a[236:239], a[188:191], v[112:127]
  buffer_load_dwordx4 v10, s[32:35], s72 offen offset:1024 lds
  ds_read_b64_tr_b16 a[248:249], v38 offset:45056
  ds_read_b64_tr_b16 a[250:251], v38 offset:45568
  v_mfma_f32_32x32x16_bf16 v[96:111], a[232:235], a[72:75], v[96:111]
  v_mfma_f32_32x32x16_bf16 v[112:127], a[232:235], a[184:187], v[112:127]
  s_add_u32 m0, s98, 49152
  s_nop 0
  buffer_load_dwordx4 v9, s[32:35], s73 offen offset:0 lds
  ds_read_b64_tr_b16 a[252:253], v38 offset:47104
  ds_read_b64_tr_b16 a[254:255], v38 offset:47616
  s_waitcnt lgkmcnt(4)
  v_mfma_f32_32x32x16_bf16 v[96:111], a[244:247], a[84:87], v[96:111]
  buffer_load_dwordx4 v10, s[32:35], s73 offen offset:1024 lds
  v_mfma_f32_32x32x16_bf16 v[112:127], a[244:247], a[196:199], v[112:127]
  ds_read_b64_tr_b16 a[224:225], v38 offset:49152
  ds_read_b64_tr_b16 a[226:227], v38 offset:49664
  v_mfma_f32_32x32x16_bf16 v[96:111], a[240:243], a[80:83], v[96:111]
  s_add_u32 m0, s4, 0
  s_add_u32 s9, s18, 0
  buffer_load_dwordx4 v53, s[40:43], s9 offen offset:0 lds
  v_mfma_f32_32x32x16_bf16 v[112:127], a[240:243], a[192:195], v[112:127]
  ds_read_b64_tr_b16 a[228:229], v38 offset:51200
  ds_read_b64_tr_b16 a[230:231], v38 offset:51712
  s_waitcnt lgkmcnt(4)
  v_mfma_f32_32x32x16_bf16 v[96:111], a[252:255], a[92:95], v[96:111]
  buffer_load_dwordx4 v54, s[40:43], s9 offen offset:1024 lds
  v_mfma_f32_32x32x16_bf16 v[112:127], a[252:255], a[204:207], v[112:127]
  buffer_load_dwordx4 v55, s[40:43], s9 offen offset:2048 lds
  ds_read_b64_tr_b16 a[232:233], v38 offset:53248
  ds_read_b64_tr_b16 a[234:235], v38 offset:53760
  v_mfma_f32_32x32x16_bf16 v[96:111], a[248:251], a[88:91], v[96:111]
  v_mfma_f32_32x32x16_bf16 v[112:127], a[248:251], a[200:203], v[112:127]
  buffer_load_dwordx4 v56, s[40:43], s9 offen offset:3072 lds
  ds_read_b64_tr_b16 a[236:237], v38 offset:55296
  ds_read_b64_tr_b16 a[238:239], v38 offset:55808
  s_waitcnt lgkmcnt(4)
  v_mfma_f32_32x32x16_bf16 v[96:111], a[228:231], a[100:103], v[96:111]
  s_add_u32 m0, s4, 4096
  s_add_u32 s9, s18, 28672
  v_mfma_f32_32x32x16_bf16 v[112:127], a[228:231], a[212:215], v[112:127]
  buffer_load_dwordx4 v53, s[40:43], s9 offen offset:0 lds
  v_mfma_f32_32x32x16_bf16 v[96:111], a[224:227], a[96:99], v[96:111]
  buffer_load_dwordx4 v54, s[40:43], s9 offen offset:1024 lds
  v_mfma_f32_32x32x16_bf16 v[112:127], a[224:227], a[208:211], v[112:127]
  s_waitcnt lgkmcnt(0)
  v_mfma_f32_32x32x16_bf16 v[96:111], a[236:239], a[108:111], v[96:111]
  buffer_load_dwordx4 v55, s[40:43], s9 offen offset:2048 lds
  v_mfma_f32_32x32x16_bf16 v[112:127], a[236:239], a[220:223], v[112:127]
  buffer_load_dwordx4 v56, s[40:43], s9 offen offset:3072 lds
  v_mfma_f32_32x32x16_bf16 v[96:111], a[232:235], a[104:107], v[96:111]
  v_mfma_f32_32x32x16_bf16 v[112:127], a[232:235], a[216:219], v[112:127]
  s_barrier
  s_nop 9
  v_mov_b32 v40, v108
  v_mov_b32 v41, v124
  v_cvt_pk_bf16_f32 v176, v96, v97
  v_cvt_pk_bf16_f32 v177, v98, v99
  v_cvt_pk_bf16_f32 v178, v100, v101
  v_cvt_pk_bf16_f32 v179, v102, v103
  v_cvt_pk_bf16_f32 v180, v104, v105
  v_cvt_pk_bf16_f32 v181, v106, v107
  v_cvt_pk_bf16_f32 v182, v108, v109
  v_cvt_pk_bf16_f32 v183, v110, v111
  s_waitcnt vmcnt(24)
  v_mfma_f32_32x32x16_bf16 v[128:143], v[16:19], v[176:179], 0
  v_mfma_f32_32x32x16_bf16 v[128:143], v[20:23], v[180:183], v[128:143]
  v_cvt_pk_bf16_f32 v184, v112, v113
  v_cvt_pk_bf16_f32 v185, v114, v115
  v_cvt_pk_bf16_f32 v186, v116, v117
  v_cvt_pk_bf16_f32 v187, v118, v119
  v_cvt_pk_bf16_f32 v188, v120, v121
  v_cvt_pk_bf16_f32 v189, v122, v123
  v_cvt_pk_bf16_f32 v190, v124, v125
  v_cvt_pk_bf16_f32 v191, v126, v127
  v_mfma_f32_32x32x16_bf16 v[144:159], v[16:19], v[184:187], 0
  s_nop 0
  v_mfma_f32_32x32x16_bf16 v[144:159], v[20:23], v[188:191], v[144:159]
  v_cmp_eq_u32 vcc, 0, v50
s_cbranch_vccnz L_nonce7
L_nonce7_back:
  v_readfirstlane_b32 s74, v50
  v_readfirstlane_b32 s75, v51
  s_add_u32 s82, s100, 12713984
  s_waitcnt vmcnt(22)
  buffer_store_dwordx2 v[50:51], v52, s[36:39], s82 offen sc1
  v_mul_f32 v40, s90, v40
  v_min_f32 v40, 0x42a00000, v40
  v_exp_f32 v40, v40
  v_mul_f32 v41, s90, v41
  v_min_f32 v41, 0x42a00000, v41
  v_exp_f32 v41, v41
  v_add_f32 v192, 1.0, v40
  v_rcp_f32 v192, v192
  v_lshlrev_b32 v13, 2, v1
  v_bfrev_b32 v32, 1
  v_cndmask_b32 v13, v32, v13, s[92:93]
  buffer_store_dword v192, v13, s[36:39], s14 offen sc1
  v_max3_f32 v208, v128, v129, v130
  v_min3_f32 v209, v128, v129, v130
  v_max3_f32 v208, v208, v131, v132
  v_min3_f32 v209, v209, v131, v132
  v_max3_f32 v208, v208, v133, v134
  v_min3_f32 v209, v209, v133, v134
  v_max3_f32 v208, v208, v135, v136
  v_min3_f32 v209, v209, v135, v136
  v_max3_f32 v208, v208, v137, v138
  v_min3_f32 v209, v209, v137, v138
  v_max3_f32 v208, v208, v139, v140
  v_min3_f32 v209, v209, v139, v140
  v_max3_f32 v208, v208, v141, v142
  v_min3_f32 v209, v209, v141, v142
  v_max_f32 v208, v208, v143
  v_max_f32 v209, -v209, -v143
  s_nop 1
  v_permlane32_swap_b32 v208, v209
  v_max_f32 v208, v208, v209
  v_mul_f32 v210, -v208, s90
  v_mul_f32 v212, -v208, s90
  s_nop 1
  v_permlane32_swap_b32 v210, v212
  v_add_f32 v211, v210, v11
  v_add_f32 v213, v212, v11
  v_pk_fma_f32 v[192:193], v[128:129], s[90:91], v[210:211] op_sel:[0,0,0] op_sel_hi:[1,1,0]
  v_pk_fma_f32 v[128:129], v[128:129], s[90:91], v[212:213] op_sel:[0,0,0] op_sel_hi:[1,1,0] neg_lo:[1,0,0] neg_hi:[1,0,0]
  v_pk_fma_f32 v[194:195], v[130:131], s[90:91], v[210:211] op_sel:[0,0,0] op_sel_hi:[1,1,0]
  v_pk_fma_f32 v[130:131], v[130:131], s[90:91], v[212:213] op_sel:[0,0,0] op_sel_hi:[1,1,0] neg_lo:[1,0,0] neg_hi:[1,0,0]
  v_exp_f32 v192, v192
  v_exp_f32 v128, v128
  s_add_u32 m0, s4, 8192
  v_exp_f32 v193, v193
  v_exp_f32 v129, v129
  s_add_u32 s9, s19, 229376
  v_exp_f32 v194, v194
  v_exp_f32 v130, v130
  buffer_load_dwordx4 v53, s[40:43], s9 offen offset:0 lds
  v_exp_f32 v195, v195
  v_exp_f32 v131, v131
  v_pk_fma_f32 v[196:197], v[132:133], s[90:91], v[210:211] op_sel:[0,0,0] op_sel_hi:[1,1,0]
  v_pk_fma_f32 v[132:133], v[132:133], s[90:91], v[212:213] op_sel:[0,0,0] op_sel_hi:[1,1,0] neg_lo:[1,0,0] neg_hi:[1,0,0]
  v_pk_fma_f32 v[198:199], v[134:135], s[90:91], v[210:211] op_sel:[0,0,0] op_sel_hi:[1,1,0]
  v_pk_fma_f32 v[134:135], v[134:135], s[90:91], v[212:213] op_sel:[0,0,0] op_sel_hi:[1,1,0] neg_lo:[1,0,0] neg_hi:[1,0,0]
  v_exp_f32 v196, v196
  v_exp_f32 v132, v132
  v_exp_f32 v197, v197
  v_exp_f32 v133, v133
  v_exp_f32 v198, v198
  buffer_load_dwordx4 v54, s[40:43], s9 offen offset:1024 lds
  v_exp_f32 v134, v134
  v_exp_f32 v199, v199
  v_exp_f32 v135, v135
  v_pk_fma_f32 v[200:201], v[136:137], s[90:91], v[210:211] op_sel:[0,0,0] op_sel_hi:[1,1,0]
  v_pk_fma_f32 v[136:137], v[136:137], s[90:91], v[212:213] op_sel:[0,0,0] op_sel_hi:[1,1,0] neg_lo:[1,0,0] neg_hi:[1,0,0]
  v_pk_fma_f32 v[202:203], v[138:139], s[90:91], v[210:211] op_sel:[0,0,0] op_sel_hi:[1,1,0]
  v_pk_fma_f32 v[138:139], v[138:139], s[90:91], v[212:213] op_sel:[0,0,0] op_sel_hi:[1,1,0] neg_lo:[1,0,0] neg_hi:[1,0,0]
  v_exp_f32 v200, v200
  v_exp_f32 v136, v136
  v_exp_f32 v201, v201
  v_exp_f32 v137, v137
  buffer_load_dwordx4 v55, s[40:43], s9 offen offset:2048 lds
  v_exp_f32 v202, v202
  v_exp_f32 v138, v138
  v_exp_f32 v203, v203
  v_exp_f32 v139, v139
  v_pk_fma_f32 v[204:205], v[140:141], s[90:91], v[210:211] op_sel:[0,0,1] op_sel_hi:[1,1,1]
  v_pk_fma_f32 v[140:141], v[140:141], s[90:91], v[212:213] op_sel:[0,0,1] op_sel_hi:[1,1,1] neg_lo:[1,0,0] neg_hi:[1,0,0]
  v_pk_fma_f32 v[206:207], v[142:143], s[90:91], v[210:211] op_sel:[0,0,1] op_sel_hi:[1,1,1]
  v_pk_fma_f32 v[142:143], v[142:143], s[90:91], v[212:213] op_sel:[0,0,1] op_sel_hi:[1,1,1] neg_lo:[1,0,0] neg_hi:[1,0,0]
  v_exp_f32 v204, v204
  v_exp_f32 v140, v140
  v_exp_f32 v205, v205
  buffer_load_dwordx4 v56, s[40:43], s9 offen offset:3072 lds
  v_exp_f32 v141, v141
  v_exp_f32 v206, v206
  v_exp_f32 v142, v142
  v_exp_f32 v207, v207
  v_exp_f32 v143, v143
  v_pk_add_f32 v[210:211], v[192:193], v[194:195]
  v_pk_add_f32 v[212:213], v[128:129], v[130:131]
  v_pk_add_f32 v[210:211], v[210:211], v[196:197]
  v_pk_add_f32 v[212:213], v[212:213], v[132:133]
  v_pk_add_f32 v[210:211], v[210:211], v[198:199]
  v_pk_add_f32 v[212:213], v[212:213], v[134:135]
  v_pk_add_f32 v[210:211], v[210:211], v[200:201]
  v_pk_add_f32 v[212:213], v[212:213], v[136:137]
  v_pk_add_f32 v[210:211], v[210:211], v[202:203]
  s_add_u32 m0, s6, 28672
  v_pk_add_f32 v[212:213], v[212:213], v[138:139]
  v_pk_add_f32 v[210:211], v[210:211], v[204:205]
  v_pk_add_f32 v[212:213], v[212:213], v[140:141]
  v_pk_add_f32 v[210:211], v[210:211], v[206:207]
  s_add_u32 s9, s8, 0
  v_pk_add_f32 v[212:213], v[212:213], v[142:143]
  v_add_f32 v208, v210, v211
  v_add_f32 v209, v212, v213
  s_nop 1
  v_permlane32_swap_b32 v208, v209
  buffer_load_dwordx4 v53, s[44:47], s9 offen offset:0 lds
  v_add_f32 v208, v208, v209
  v_rcp_f32 v208, v208
  s_nop 0
  v_mov_b32 v209, v208
  s_nop 1
  v_permlane32_swap_b32 v208, v209
  v_pk_mul_f32 v[192:193], v[192:193], v[208:209] op_sel:[0,0] op_sel_hi:[1,0]
  v_pk_mul_f32 v[194:195], v[194:195], v[208:209] op_sel:[0,0] op_sel_hi:[1,0]
  v_pk_mul_f32 v[196:197], v[196:197], v[208:209] op_sel:[0,0] op_sel_hi:[1,0]
  v_pk_mul_f32 v[198:199], v[198:199], v[208:209] op_sel:[0,0] op_sel_hi:[1,0]
  v_pk_mul_f32 v[200:201], v[200:201], v[208:209] op_sel:[0,0] op_sel_hi:[1,0]
  v_pk_mul_f32 v[202:203], v[202:203], v[208:209] op_sel:[0,0] op_sel_hi:[1,0]
  v_pk_mul_f32 v[204:205], v[204:205], v[208:209] op_sel:[0,0] op_sel_hi:[1,0]
  v_pk_mul_f32 v[206:207], v[206:207], v[208:209] op_sel:[0,0] op_sel_hi:[1,0]
  v_cvt_pk_bf16_f32 v160, v192, v193
  v_cvt_pk_bf16_f32 v161, v194, v195
  v_cvt_pk_bf16_f32 v162, v196, v197
  v_cvt_pk_bf16_f32 v163, v198, v199
  buffer_load_dwordx4 v54, s[44:47], s9 offen offset:1024 lds
  v_cvt_pk_bf16_f32 v164, v200, v201
  v_cvt_pk_bf16_f32 v165, v202, v203
  v_cvt_pk_bf16_f32 v166, v204, v205
  v_cvt_pk_bf16_f32 v167, v206, v207
  v_pk_mul_f32 v[128:129], v[128:129], v[208:209] op_sel:[0,1] op_sel_hi:[1,1]
  v_pk_mul_f32 v[130:131], v[130:131], v[208:209] op_sel:[0,1] op_sel_hi:[1,1]
  v_pk_mul_f32 v[132:133], v[132:133], v[208:209] op_sel:[0,1] op_sel_hi:[1,1]
  v_pk_mul_f32 v[134:135], v[134:135], v[208:209] op_sel:[0,1] op_sel_hi:[1,1]
  v_pk_mul_f32 v[136:137], v[136:137], v[208:209] op_sel:[0,1] op_sel_hi:[1,1]
  v_pk_mul_f32 v[138:139], v[138:139], v[208:209] op_sel:[0,1] op_sel_hi:[1,1]
  v_pk_mul_f32 v[140:141], v[140:141], v[208:209] op_sel:[0,1] op_sel_hi:[1,1]
  v_pk_mul_f32 v[142:143], v[142:143], v[208:209] op_sel:[0,1] op_sel_hi:[1,1]
  v_cvt_pk_bf16_f32 v168, v128, v129
  v_cvt_pk_bf16_f32 v169, v130, v131
  v_cvt_pk_bf16_f32 v170, v132, v133
  v_cvt_pk_bf16_f32 v171, v134, v135
  v_cvt_pk_bf16_f32 v172, v136, v137
  v_cvt_pk_bf16_f32 v173, v138, v139
  buffer_load_dwordx4 v55, s[44:47], s9 offen offset:2048 lds
  v_cvt_pk_bf16_f32 v174, v140, v141
  v_cvt_pk_bf16_f32 v175, v142, v143
  v_max3_f32 v208, v144, v145, v146
  v_min3_f32 v209, v144, v145, v146
  v_max3_f32 v208, v208, v147, v148
  v_min3_f32 v209, v209, v147, v148
  v_max3_f32 v208, v208, v149, v150
  v_min3_f32 v209, v209, v149, v150
  v_max3_f32 v208, v208, v151, v152
  v_min3_f32 v209, v209, v151, v152
  v_max3_f32 v208, v208, v153, v154
  v_min3_f32 v209, v209, v153, v154
  v_max3_f32 v208, v208, v155, v156
  v_min3_f32 v209, v209, v155, v156
  v_max3_f32 v208, v208, v157, v158
  v_min3_f32 v209, v209, v157, v158
  v_max_f32 v208, v208, v159
  v_max_f32 v209, -v209, -v159
  buffer_load_dwordx4 v56, s[44:47], s9 offen offset:3072 lds
  s_nop 0
  v_permlane32_swap_b32 v208, v209
  v_max_f32 v208, v208, v209
  v_mul_f32 v210, -v208, s90
  v_mul_f32 v212, -v208, s90
  s_nop 1
  v_permlane32_swap_b32 v210, v212
  v_add_f32 v211, v210, v11
  v_add_f32 v213, v212, v11
  v_pk_fma_f32 v[192:193], v[144:145], s[90:91], v[210:211] op_sel:[0,0,0] op_sel_hi:[1,1,0]
  v_pk_fma_f32 v[144:145], v[144:145], s[90:91], v[212:213] op_sel:[0,0,0] op_sel_hi:[1,1,0] neg_lo:[1,0,0] neg_hi:[1,0,0]
  v_pk_fma_f32 v[194:195], v[146:147], s[90:91], v[210:211] op_sel:[0,0,0] op_sel_hi:[1,1,0]
  v_pk_fma_f32 v[146:147], v[146:147], s[90:91], v[212:213] op_sel:[0,0,0] op_sel_hi:[1,1,0] neg_lo:[1,0,0] neg_hi:[1,0,0]
  v_exp_f32 v192, v192
  v_exp_f32 v144, v144
  v_exp_f32 v193, v193
  s_add_u32 m0, s6, 32768
  v_exp_f32 v145, v145
  v_exp_f32 v194, v194
  s_add_u32 s9, s8, 28672
  v_exp_f32 v146, v146
  v_exp_f32 v195, v195
  buffer_load_dwordx4 v53, s[44:47], s9 offen offset:0 lds
  v_exp_f32 v147, v147
  v_pk_fma_f32 v[196:197], v[148:149], s[90:91], v[210:211] op_sel:[0,0,0] op_sel_hi:[1,1,0]
  v_pk_fma_f32 v[148:149], v[148:149], s[90:91], v[212:213] op_sel:[0,0,0] op_sel_hi:[1,1,0] neg_lo:[1,0,0] neg_hi:[1,0,0]
  v_pk_fma_f32 v[198:199], v[150:151], s[90:91], v[210:211] op_sel:[0,0,0] op_sel_hi:[1,1,0]
  v_pk_fma_f32 v[150:151], v[150:151], s[90:91], v[212:213] op_sel:[0,0,0] op_sel_hi:[1,1,0] neg_lo:[1,0,0] neg_hi:[1,0,0]
  v_exp_f32 v196, v196
  v_exp_f32 v148, v148
  v_exp_f32 v197, v197
  v_exp_f32 v149, v149
  v_exp_f32 v198, v198
  v_exp_f32 v150, v150
  buffer_load_dwordx4 v54, s[44:47], s9 offen offset:1024 lds
  v_exp_f32 v199, v199
  v_exp_f32 v151, v151
  v_pk_fma_f32 v[200:201], v[152:153], s[90:91], v[210:211] op_sel:[0,0,0] op_sel_hi:[1,1,0]
  v_pk_fma_f32 v[152:153], v[152:153], s[90:91], v[212:213] op_sel:[0,0,0] op_sel_hi:[1,1,0] neg_lo:[1,0,0] neg_hi:[1,0,0]
  v_pk_fma_f32 v[202:203], v[154:155], s[90:91], v[210:211] op_sel:[0,0,0] op_sel_hi:[1,1,0]
  v_pk_fma_f32 v[154:155], v[154:155], s[90:91], v[212:213] op_sel:[0,0,0] op_sel_hi:[1,1,0] neg_lo:[1,0,0] neg_hi:[1,0,0]
  v_exp_f32 v200, v200
  v_exp_f32 v152, v152
  v_exp_f32 v201, v201
  v_exp_f32 v153, v153
  v_exp_f32 v202, v202
  buffer_load_dwordx4 v55, s[44:47], s9 offen offset:2048 lds
  v_exp_f32 v154, v154
  v_exp_f32 v203, v203
  v_exp_f32 v155, v155
  v_pk_fma_f32 v[204:205], v[156:157], s[90:91], v[210:211] op_sel:[0,0,1] op_sel_hi:[1,1,1]
  v_pk_fma_f32 v[156:157], v[156:157], s[90:91], v[212:213] op_sel:[0,0,1] op_sel_hi:[1,1,1] neg_lo:[1,0,0] neg_hi:[1,0,0]
  v_pk_fma_f32 v[206:207], v[158:159], s[90:91], v[210:211] op_sel:[0,0,1] op_sel_hi:[1,1,1]
  v_pk_fma_f32 v[158:159], v[158:159], s[90:91], v[212:213] op_sel:[0,0,1] op_sel_hi:[1,1,1] neg_lo:[1,0,0] neg_hi:[1,0,0]
  v_exp_f32 v204, v204
  v_exp_f32 v156, v156
  v_exp_f32 v205, v205
  v_exp_f32 v157, v157
  v_exp_f32 v206, v206
  v_exp_f32 v158, v158
  v_exp_f32 v207, v207
  v_exp_f32 v159, v159
  v_pk_add_f32 v[210:211], v[192:193], v[194:195]
  v_pk_add_f32 v[212:213], v[144:145], v[146:147]
  v_pk_add_f32 v[210:211], v[210:211], v[196:197]
  v_pk_add_f32 v[212:213], v[212:213], v[148:149]
  v_pk_add_f32 v[210:211], v[210:211], v[198:199]
  v_pk_add_f32 v[212:213], v[212:213], v[150:151]
  v_pk_add_f32 v[210:211], v[210:211], v[200:201]
  v_pk_add_f32 v[212:213], v[212:213], v[152:153]
  v_pk_add_f32 v[210:211], v[210:211], v[202:203]
  v_pk_add_f32 v[212:213], v[212:213], v[154:155]
  v_pk_add_f32 v[210:211], v[210:211], v[204:205]
  v_pk_add_f32 v[212:213], v[212:213], v[156:157]
  v_pk_add_f32 v[210:211], v[210:211], v[206:207]
  v_pk_add_f32 v[212:213], v[212:213], v[158:159]
  v_add_f32 v208, v210, v211
  v_add_f32 v209, v212, v213
  s_nop 1
  v_permlane32_swap_b32 v208, v209
  v_add_f32 v208, v208, v209
  v_rcp_f32 v208, v208
  s_nop 0
  v_mov_b32 v209, v208
  s_nop 1
  v_permlane32_swap_b32 v208, v209
  v_pk_mul_f32 v[192:193], v[192:193], v[208:209] op_sel:[0,0] op_sel_hi:[1,0]
  v_pk_mul_f32 v[194:195], v[194:195], v[208:209] op_sel:[0,0] op_sel_hi:[1,0]
  v_pk_mul_f32 v[196:197], v[196:197], v[208:209] op_sel:[0,0] op_sel_hi:[1,0]
  v_pk_mul_f32 v[198:199], v[198:199], v[208:209] op_sel:[0,0] op_sel_hi:[1,0]
  v_pk_mul_f32 v[200:201], v[200:201], v[208:209] op_sel:[0,0] op_sel_hi:[1,0]
  s_waitcnt vmcnt(21)
  s_barrier
  ds_read_b64_tr_b16 a[224:225], v37 offset:0
  ds_read_b64_tr_b16 a[226:227], v37 offset:512
  ds_read_b64_tr_b16 a[228:229], v37 offset:2048
  ds_read_b64_tr_b16 a[230:231], v37 offset:2560
  ds_read_b64_tr_b16 a[232:233], v37 offset:4096
  ds_read_b64_tr_b16 a[234:235], v37 offset:4608
  ds_read_b64_tr_b16 a[236:237], v37 offset:6144
  ds_read_b64_tr_b16 a[238:239], v37 offset:6656
  v_pk_mul_f32 v[202:203], v[202:203], v[208:209] op_sel:[0,0] op_sel_hi:[1,0]
  v_pk_mul_f32 v[204:205], v[204:205], v[208:209] op_sel:[0,0] op_sel_hi:[1,0]
  v_pk_mul_f32 v[206:207], v[206:207], v[208:209] op_sel:[0,0] op_sel_hi:[1,0]
  v_cvt_pk_bf16_f32 v176, v192, v193
  v_cvt_pk_bf16_f32 v177, v194, v195
  v_cvt_pk_bf16_f32 v178, v196, v197
  v_cvt_pk_bf16_f32 v179, v198, v199
  v_cvt_pk_bf16_f32 v180, v200, v201
  v_cvt_pk_bf16_f32 v181, v202, v203
  v_cvt_pk_bf16_f32 v182, v204, v205
  v_cvt_pk_bf16_f32 v183, v206, v207
  v_pk_mul_f32 v[144:145], v[144:145], v[208:209] op_sel:[0,1] op_sel_hi:[1,1]
  v_pk_mul_f32 v[146:147], v[146:147], v[208:209] op_sel:[0,1] op_sel_hi:[1,1]
  v_pk_mul_f32 v[148:149], v[148:149], v[208:209] op_sel:[0,1] op_sel_hi:[1,1]
  v_pk_mul_f32 v[150:151], v[150:151], v[208:209] op_sel:[0,1] op_sel_hi:[1,1]
  v_pk_mul_f32 v[152:153], v[152:153], v[208:209] op_sel:[0,1] op_sel_hi:[1,1]
  v_pk_mul_f32 v[154:155], v[154:155], v[208:209] op_sel:[0,1] op_sel_hi:[1,1]
  v_pk_mul_f32 v[156:157], v[156:157], v[208:209] op_sel:[0,1] op_sel_hi:[1,1]
  v_pk_mul_f32 v[158:159], v[158:159], v[208:209] op_sel:[0,1] op_sel_hi:[1,1]
  v_cvt_pk_bf16_f32 v184, v144, v145
  v_cvt_pk_bf16_f32 v185, v146, v147
  v_cvt_pk_bf16_f32 v186, v148, v149
  v_cvt_pk_bf16_f32 v187, v150, v151
  v_cvt_pk_bf16_f32 v188, v152, v153
  v_cvt_pk_bf16_f32 v189, v154, v155
  v_cvt_pk_bf16_f32 v190, v156, v157
  v_cvt_pk_bf16_f32 v191, v158, v159
  s_add_u32 s13, s13, 8192
  s_waitcnt lgkmcnt(4)
  v_mfma_f32_32x32x16_bf16 v[64:79], a[228:231], a[4:7], v[64:79]
  s_waitcnt vmcnt(7)
  ds_read_b64_tr_b16 v[128:129], v59 offset:0
  v_mfma_f32_32x32x16_bf16 v[80:95], a[228:231], a[116:119], v[80:95]
  ds_read_b64_tr_b16 v[130:131], v59 offset:1024
  ds_read_b64_tr_b16 v[132:133], v60 offset:0
  ds_read_b64_tr_b16 v[134:135], v60 offset:1024
  ds_read_b64_tr_b16 a[240:241], v37 offset:8192
  ds_read_b64_tr_b16 a[242:243], v37 offset:8704
  v_mfma_f32_32x32x16_bf16 v[64:79], a[224:227], a[0:3], v[64:79]
  ds_read_b64_tr_b16 v[136:137], v59 offset:2048
  ds_read_b64_tr_b16 v[138:139], v59 offset:3072
  v_mfma_f32_32x32x16_bf16 v[80:95], a[224:227], a[112:115], v[80:95]
  ds_read_b64_tr_b16 v[140:141], v60 offset:2048
  ds_read_b64_tr_b16 v[142:143], v60 offset:3072
  ds_read_b64_tr_b16 a[244:245], v37 offset:10240
  ds_read_b64_tr_b16 a[246:247], v37 offset:10752
  s_waitcnt lgkmcnt(12)
  v_mfma_f32_32x32x16_bf16 v[64:79], a[236:239], a[12:15], v[64:79]
  ds_read_b64_tr_b16 v[144:145], v59 offset:4096
  ds_read_b64_tr_b16 v[146:147], v59 offset:5120
  v_mfma_f32_32x32x16_bf16 v[80:95], a[236:239], a[124:127], v[80:95]
  ds_read_b64_tr_b16 v[148:149], v60 offset:4096
  ds_read_b64_tr_b16 v[150:151], v60 offset:5120
  ds_read_b64_tr_b16 a[248:249], v37 offset:12288
  ds_read_b64_tr_b16 a[250:251], v37 offset:12800
  v_mfma_f32_32x32x16_bf16 v[64:79], a[232:235], a[8:11], v[64:79]
  ds_read_b64_tr_b16 v[152:153], v59 offset:6144
  ds_read_b64_tr_b16 v[154:155], v59 offset:7168
  ds_read_b64_tr_b16 v[156:157], v60 offset:6144
  v_mfma_f32_32x32x16_bf16 v[80:95], a[232:235], a[120:123], v[80:95]
  ds_read_b64_tr_b16 v[158:159], v60 offset:7168
  ds_read_b64_tr_b16 v[16:17], v59 offset:8192
  ds_read_b64_tr_b16 a[252:253], v37 offset:14336
  ds_read_b64_tr_b16 a[254:255], v37 offset:14848
  s_waitcnt lgkmcnt(13)
  v_mfma_f32_32x32x16_bf16 v[64:79], a[244:247], a[20:23], v[64:79]
  ds_read_b64_tr_b16 v[18:19], v59 offset:9216
  ds_read_b64_tr_b16 v[20:21], v60 offset:8192
  v_mfma_f32_32x32x16_bf16 v[80:95], a[244:247], a[132:135], v[80:95]
  ds_read_b64_tr_b16 v[22:23], v60 offset:9216
  ds_read_b64_tr_b16 v[224:225], v59 offset:10240
  ds_read_b64_tr_b16 a[224:225], v37 offset:16384
  ds_read_b64_tr_b16 a[226:227], v37 offset:16896
  v_mfma_f32_32x32x16_bf16 v[64:79], a[240:243], a[16:19], v[64:79]
  ds_read_b64_tr_b16 v[226:227], v59 offset:11264
  ds_read_b64_tr_b16 v[228:229], v60 offset:10240
  v_mfma_f32_32x32x16_bf16 v[80:95], a[240:243], a[128:131], v[80:95]
  ds_read_b64_tr_b16 v[230:231], v60 offset:11264
  s_waitcnt lgkmcnt(0)
  s_add_u32 m0, s4, 0
  s_add_u32 s9, s19, 258048
  ds_read_b64_tr_b16 a[228:229], v37 offset:18432
  ds_read_b64_tr_b16 a[230:231], v37 offset:18944
  v_mfma_f32_32x32x16_bf16 v[64:79], a[252:255], a[28:31], v[64:79]
  buffer_load_dwordx4 v53, s[40:43], s9 offen offset:0 lds
  v_mfma_f32_32x32x16_bf16 v[80:95], a[252:255], a[140:143], v[80:95]
  ds_read_b64_tr_b16 a[232:233], v37 offset:20480
  ds_read_b64_tr_b16 a[234:235], v37 offset:20992
  v_mfma_f32_32x32x16_bf16 v[64:79], a[248:251], a[24:27], v[64:79]
  buffer_load_dwordx4 v54, s[40:43], s9 offen offset:1024 lds
  v_mfma_f32_32x32x16_bf16 v[80:95], a[248:251], a[136:139], v[80:95]
  ds_read_b64_tr_b16 a[236:237], v37 offset:22528
  ds_read_b64_tr_b16 a[238:239], v37 offset:23040
  s_waitcnt lgkmcnt(4)
  v_mfma_f32_32x32x16_bf16 v[64:79], a[228:231], a[36:39], v[64:79]
  buffer_load_dwordx4 v55, s[40:43], s9 offen offset:2048 lds
  v_mfma_f32_32x32x16_bf16 v[80:95], a[228:231], a[148:151], v[80:95]
  ds_read_b64_tr_b16 a[240:241], v37 offset:24576
  ds_read_b64_tr_b16 a[242:243], v37 offset:25088
  v_mfma_f32_32x32x16_bf16 v[64:79], a[224:227], a[32:35], v[64:79]
  buffer_load_dwordx4 v56, s[40:43], s9 offen offset:3072 lds
  v_mfma_f32_32x32x16_bf16 v[80:95], a[224:227], a[144:147], v[80:95]
  ds_read_b64_tr_b16 a[244:245], v37 offset:26624
  ds_read_b64_tr_b16 a[246:247], v37 offset:27136
  s_waitcnt lgkmcnt(4)
  v_mfma_f32_32x32x16_bf16 v[64:79], a[236:239], a[44:47], v[64:79]
  s_add_u32 m0, s4, 4096
  v_mfma_f32_32x32x16_bf16 v[80:95], a[236:239], a[156:159], v[80:95]
  s_add_u32 s9, s18, 57344
  buffer_load_dwordx4 v53, s[40:43], s9 offen offset:0 lds
  ds_read_b64_tr_b16 a[248:249], v37 offset:28672
  ds_read_b64_tr_b16 a[250:251], v37 offset:29184
  v_mfma_f32_32x32x16_bf16 v[64:79], a[232:235], a[40:43], v[64:79]
  v_mfma_f32_32x32x16_bf16 v[80:95], a[232:235], a[152:155], v[80:95]
  buffer_load_dwordx4 v54, s[40:43], s9 offen offset:1024 lds
  ds_read_b64_tr_b16 a[252:253], v37 offset:30720
  ds_read_b64_tr_b16 a[254:255], v37 offset:31232
  s_waitcnt lgkmcnt(4)
  v_mfma_f32_32x32x16_bf16 v[64:79], a[244:247], a[52:55], v[64:79]
  v_mfma_f32_32x32x16_bf16 v[80:95], a[244:247], a[164:167], v[80:95]
  buffer_load_dwordx4 v55, s[40:43], s9 offen offset:2048 lds
  ds_read_b64_tr_b16 a[224:225], v37 offset:32768
  ds_read_b64_tr_b16 a[226:227], v37 offset:33280
  v_mfma_f32_32x32x16_bf16 v[64:79], a[240:243], a[48:51], v[64:79]
  v_mfma_f32_32x32x16_bf16 v[80:95], a[240:243], a[160:163], v[80:95]
  buffer_load_dwordx4 v56, s[40:43], s9 offen offset:3072 lds
  ds_read_b64_tr_b16 a[228:229], v37 offset:34816
  ds_read_b64_tr_b16 a[230:231], v37 offset:35328
  s_waitcnt lgkmcnt(4)
  v_mfma_f32_32x32x16_bf16 v[64:79], a[252:255], a[60:63], v[64:79]
  v_mfma_f32_32x32x16_bf16 v[80:95], a[252:255], a[172:175], v[80:95]
  s_add_u32 m0, s4, 8192
  ds_read_b64_tr_b16 a[232:233], v37 offset:36864
  ds_read_b64_tr_b16 a[234:235], v37 offset:37376
  v_mfma_f32_32x32x16_bf16 v[64:79], a[248:251], a[56:59], v[64:79]
  s_add_u32 s9, s18, 86016
  buffer_load_dwordx4 v53, s[40:43], s9 offen offset:0 lds
  v_mfma_f32_32x32x16_bf16 v[80:95], a[248:251], a[168:171], v[80:95]
  ds_read_b64_tr_b16 a[236:237], v37 offset:38912
  ds_read_b64_tr_b16 a[238:239], v37 offset:39424
  s_waitcnt lgkmcnt(4)
  v_mfma_f32_32x32x16_bf16 v[64:79], a[228:231], a[68:71], v[64:79]
  buffer_load_dwordx4 v54, s[40:43], s9 offen offset:1024 lds
  v_mfma_f32_32x32x16_bf16 v[80:95], a[228:231], a[180:183], v[80:95]
  ds_read_b64_tr_b16 a[240:241], v37 offset:40960
  ds_read_b64_tr_b16 a[242:243], v37 offset:41472
  v_mfma_f32_32x32x16_bf16 v[64:79], a[224:227], a[64:67], v[64:79]
  buffer_load_dwordx4 v55, s[40:43], s9 offen offset:2048 lds
  v_mfma_f32_32x32x16_bf16 v[80:95], a[224:227], a[176:179], v[80:95]
  ds_read_b64_tr_b16 a[244:245], v37 offset:43008
  ds_read_b64_tr_b16 a[246:247], v37 offset:43520
  s_waitcnt lgkmcnt(4)
  v_mfma_f32_32x32x16_bf16 v[64:79], a[236:239], a[76:79], v[64:79]
  buffer_load_dwordx4 v56, s[40:43], s9 offen offset:3072 lds
  v_mfma_f32_32x32x16_bf16 v[80:95], a[236:239], a[188:191], v[80:95]
  ds_read_b64_tr_b16 a[248:249], v37 offset:45056
  ds_read_b64_tr_b16 a[250:251], v37 offset:45568
  v_mfma_f32_32x32x16_bf16 v[64:79], a[232:235], a[72:75], v[64:79]
  s_add_u32 m0, s6, 0
  v_mfma_f32_32x32x16_bf16 v[80:95], a[232:235], a[184:187], v[80:95]
  s_add_u32 s9, s3, 50176
  buffer_load_dwordx4 v53, s[44:47], s9 offen offset:0 lds
  ds_read_b64_tr_b16 a[252:253], v37 offset:47104
  ds_read_b64_tr_b16 a[254:255], v37 offset:47616
  s_waitcnt lgkmcnt(4)
  v_mfma_f32_32x32x16_bf16 v[64:79], a[244:247], a[84:87], v[64:79]
  v_mfma_f32_32x32x16_bf16 v[80:95], a[244:247], a[196:199], v[80:95]
  buffer_load_dwordx4 v54, s[44:47], s9 offen offset:1024 lds
  ds_read_b64_tr_b16 a[224:225], v37 offset:49152
  ds_read_b64_tr_b16 a[226:227], v37 offset:49664
  v_mfma_f32_32x32x16_bf16 v[64:79], a[240:243], a[80:83], v[64:79]
  v_mfma_f32_32x32x16_bf16 v[80:95], a[240:243], a[192:195], v[80:95]
  buffer_load_dwordx4 v55, s[44:47], s9 offen offset:2048 lds
  ds_read_b64_tr_b16 a[228:229], v37 offset:51200
  ds_read_b64_tr_b16 a[230:231], v37 offset:51712
  s_waitcnt lgkmcnt(4)
  v_mfma_f32_32x32x16_bf16 v[64:79], a[252:255], a[92:95], v[64:79]
  s_mov_b32 s17, 12582912
  buffer_load_dwordx2 v[44:45], v58, s[36:39], s17 offen sc1
  v_mfma_f32_32x32x16_bf16 v[80:95], a[252:255], a[204:207], v[80:95]
  buffer_load_dwordx4 v56, s[44:47], s9 offen offset:3072 lds
  ds_read_b64_tr_b16 a[232:233], v37 offset:53248
  ds_read_b64_tr_b16 a[234:235], v37 offset:53760
  v_mfma_f32_32x32x16_bf16 v[64:79], a[248:251], a[88:91], v[64:79]
  v_mfma_f32_32x32x16_bf16 v[80:95], a[248:251], a[200:203], v[80:95]
  s_add_u32 m0, s6, 4096
  ds_read_b64_tr_b16 a[236:237], v37 offset:55296
  ds_read_b64_tr_b16 a[238:239], v37 offset:55808
  s_waitcnt lgkmcnt(4)
  v_mfma_f32_32x32x16_bf16 v[64:79], a[228:231], a[100:103], v[64:79]
  s_add_u32 s9, s3, 78848
  buffer_load_dwordx4 v53, s[44:47], s9 offen offset:0 lds
  v_mfma_f32_32x32x16_bf16 v[80:95], a[228:231], a[212:215], v[80:95]
  v_mfma_f32_32x32x16_bf16 v[64:79], a[224:227], a[96:99], v[64:79]
  buffer_load_dwordx4 v54, s[44:47], s9 offen offset:1024 lds
  v_mfma_f32_32x32x16_bf16 v[80:95], a[224:227], a[208:211], v[80:95]
  s_waitcnt lgkmcnt(0)
  v_mfma_f32_32x32x16_bf16 v[64:79], a[236:239], a[108:111], v[64:79]
  buffer_load_dwordx4 v55, s[44:47], s9 offen offset:2048 lds
  v_mfma_f32_32x32x16_bf16 v[80:95], a[236:239], a[220:223], v[80:95]
  v_mfma_f32_32x32x16_bf16 v[64:79], a[232:235], a[104:107], v[64:79]
  v_mfma_f32_32x32x16_bf16 v[80:95], a[232:235], a[216:219], v[80:95]
  s_barrier
  s_lshl2_add_u32 s76, s86, s56
  s_lshl_b32 s76, s76, 9
  s_add_u32 s76, s76, 12582912
  s_add_u32 s20, s26, s76
  s_addc_u32 s21, s27, 0
  s_load_dwordx2 s[60:61], s[20:21], 0x20000 glc
  s_load_dwordx2 s[62:63], s[20:21], 0x20080 glc
  s_load_dwordx2 s[64:65], s[20:21], 0x20100 glc
  s_load_dwordx2 s[66:67], s[20:21], 0x20180 glc
  s_waitcnt vmcnt(4)
  v_cmp_ne_u64 vcc, s[74:75], v[44:45]
s_cbranch_vccnz L_poll8
L_poll8_back:
  buffer_load_dwordx4 v[96:99], v4, s[36:39], s12 offen sc1
  buffer_load_dwordx4 v[100:103], v4, s[36:39], s12 offen offset:1024 sc1
  s_add_u32 s12, s15, 11534336
  s_add_u32 s15, s15, 12648448
  v_pk_mul_f32 v[192:193], v[64:65], s[90:91]
  v_pk_mul_f32 v[194:195], v[66:67], s[90:91]
  v_exp_f32 v192, v192
  v_exp_f32 v193, v193
  v_exp_f32 v194, v194
  v_exp_f32 v195, v195
  v_pk_fma_f32 v[192:193], v[192:193], v[14:15], v[14:15]
  v_pk_fma_f32 v[194:195], v[194:195], v[14:15], v[14:15]
  v_pk_fma_f32 v[192:193], v[192:193], v[192:193], 0.5 op_sel_hi:[1,1,0]
  v_pk_fma_f32 v[194:195], v[194:195], v[194:195], 0.5 op_sel_hi:[1,1,0]
  v_rcp_f32 v192, v192
  v_rcp_f32 v193, v193
  v_rcp_f32 v194, v194
  v_rcp_f32 v195, v195
  v_pk_fma_f32 v[192:193], v[64:65], v[192:193], v[64:65] neg_lo:[1,0,0] neg_hi:[1,0,0]
  v_pk_fma_f32 v[194:195], v[66:67], v[194:195], v[66:67] neg_lo:[1,0,0] neg_hi:[1,0,0]
  v_cvt_pk_bf16_f32 v200, v192, v193
  v_cvt_pk_bf16_f32 v201, v194, v195
  v_pk_mul_f32 v[196:197], v[68:69], s[90:91]
  v_pk_mul_f32 v[198:199], v[70:71], s[90:91]
  v_exp_f32 v196, v196
  v_exp_f32 v197, v197
  v_exp_f32 v198, v198
  v_exp_f32 v199, v199
  v_pk_fma_f32 v[196:197], v[196:197], v[14:15], v[14:15]
  v_pk_fma_f32 v[198:199], v[198:199], v[14:15], v[14:15]
  v_pk_fma_f32 v[196:197], v[196:197], v[196:197], 0.5 op_sel_hi:[1,1,0]
  v_pk_fma_f32 v[198:199], v[198:199], v[198:199], 0.5 op_sel_hi:[1,1,0]
  v_rcp_f32 v196, v196
  v_rcp_f32 v197, v197
  v_rcp_f32 v198, v198
  v_rcp_f32 v199, v199
  v_pk_fma_f32 v[196:197], v[68:69], v[196:197], v[68:69] neg_lo:[1,0,0] neg_hi:[1,0,0]
  v_pk_fma_f32 v[198:199], v[70:71], v[198:199], v[70:71] neg_lo:[1,0,0] neg_hi:[1,0,0]
  v_cvt_pk_bf16_f32 v202, v196, v197
  v_cvt_pk_bf16_f32 v203, v198, v199
  buffer_store_dwordx4 v[200:203], v39, s[36:39], s13 offen offset:0 sc1
  v_pk_mul_f32 v[192:193], v[72:73], s[90:91]
  v_pk_mul_f32 v[194:195], v[74:75], s[90:91]
  v_exp_f32 v192, v192
  v_exp_f32 v193, v193
  v_exp_f32 v194, v194
  v_exp_f32 v195, v195
  v_pk_fma_f32 v[192:193], v[192:193], v[14:15], v[14:15]
  v_pk_fma_f32 v[194:195], v[194:195], v[14:15], v[14:15]
  v_pk_fma_f32 v[192:193], v[192:193], v[192:193], 0.5 op_sel_hi:[1,1,0]
  v_pk_fma_f32 v[194:195], v[194:195], v[194:195], 0.5 op_sel_hi:[1,1,0]
  v_rcp_f32 v192, v192
  v_rcp_f32 v193, v193
  v_rcp_f32 v194, v194
  v_rcp_f32 v195, v195
  v_pk_fma_f32 v[192:193], v[72:73], v[192:193], v[72:73] neg_lo:[1,0,0] neg_hi:[1,0,0]
  v_pk_fma_f32 v[194:195], v[74:75], v[194:195], v[74:75] neg_lo:[1,0,0] neg_hi:[1,0,0]
  v_cvt_pk_bf16_f32 v204, v192, v193
  v_cvt_pk_bf16_f32 v205, v194, v195
  v_pk_mul_f32 v[196:197], v[76:77], s[90:91]
  v_pk_mul_f32 v[198:199], v[78:79], s[90:91]
  v_exp_f32 v196, v196
  v_exp_f32 v197, v197
  v_exp_f32 v198, v198
  v_exp_f32 v199, v199
  v_pk_fma_f32 v[196:197], v[196:197], v[14:15], v[14:15]
  v_pk_fma_f32 v[198:199], v[198:199], v[14:15], v[14:15]
  v_pk_fma_f32 v[196:197], v[196:197], v[196:197], 0.5 op_sel_hi:[1,1,0]
  v_pk_fma_f32 v[198:199], v[198:199], v[198:199], 0.5 op_sel_hi:[1,1,0]
  v_rcp_f32 v196, v196
  v_rcp_f32 v197, v197
  v_rcp_f32 v198, v198
  v_rcp_f32 v199, v199
  v_pk_fma_f32 v[196:197], v[76:77], v[196:197], v[76:77] neg_lo:[1,0,0] neg_hi:[1,0,0]
  v_pk_fma_f32 v[198:199], v[78:79], v[198:199], v[78:79] neg_lo:[1,0,0] neg_hi:[1,0,0]
  v_cvt_pk_bf16_f32 v206, v196, v197
  v_cvt_pk_bf16_f32 v207, v198, v199
  buffer_store_dwordx4 v[204:207], v39, s[36:39], s13 offen offset:1024 sc1
  s_waitcnt vmcnt(3)
  v_lshlrev_b32 v104, 16, v96
  v_and_b32 v105, 0xffff0000, v96
  s_waitcnt vmcnt(2)
  v_lshlrev_b32 v112, 16, v100
  v_and_b32 v113, 0xffff0000, v100
  v_lshlrev_b32 v106, 16, v97
  v_and_b32 v107, 0xffff0000, v97
  v_lshlrev_b32 v114, 16, v101
  v_and_b32 v115, 0xffff0000, v101
  v_lshlrev_b32 v108, 16, v98
  v_and_b32 v109, 0xffff0000, v98
  v_lshlrev_b32 v116, 16, v102
  v_and_b32 v117, 0xffff0000, v102
  v_lshlrev_b32 v110, 16, v99
  v_and_b32 v111, 0xffff0000, v99
  v_lshlrev_b32 v118, 16, v103
  v_and_b32 v119, 0xffff0000, v103
  v_pk_add_f32 v[104:105], v[104:105], v[112:113]
  v_pk_add_f32 v[106:107], v[106:107], v[114:115]
  v_pk_add_f32 v[108:109], v[108:109], v[116:117]
  v_pk_add_f32 v[110:111], v[110:111], v[118:119]
  s_nop 0
  v_permlane32_swap_b32 v104, v108
  v_permlane32_swap_b32 v105, v109
  v_permlane32_swap_b32 v106, v110
  v_permlane32_swap_b32 v107, v111
  v_pk_add_f32 v[104:105], v[104:105], v[108:109]
  v_pk_add_f32 v[106:107], v[106:107], v[110:111]
  s_nop 1
  v_permlane16_swap_b32 v104, v106
  v_permlane16_swap_b32 v105, v107
  v_pk_add_f32 v[104:105], v[104:105], v[106:107]
  s_nop 1
  v_add_f32_dpp v106, v104, v104 row_ror:8 row_mask:0xf bank_mask:0xf
  v_add_f32_dpp v107, v105, v105 row_ror:8 row_mask:0xf bank_mask:0xf
  v_cvt_pk_bf16_f32 v104, v106, v107
  buffer_store_dword v104, v222, s[36:39], s12 offen sc1
  v_pk_mul_f32 v[192:193], v[80:81], s[90:91]
  v_pk_mul_f32 v[194:195], v[82:83], s[90:91]
  v_exp_f32 v192, v192
  v_exp_f32 v193, v193
  v_exp_f32 v194, v194
  v_exp_f32 v195, v195
  v_pk_fma_f32 v[192:193], v[192:193], v[14:15], v[14:15]
  v_pk_fma_f32 v[194:195], v[194:195], v[14:15], v[14:15]
  v_pk_fma_f32 v[192:193], v[192:193], v[192:193], 0.5 op_sel_hi:[1,1,0]
  v_pk_fma_f32 v[194:195], v[194:195], v[194:195], 0.5 op_sel_hi:[1,1,0]
  v_rcp_f32 v192, v192
  v_rcp_f32 v193, v193
  v_rcp_f32 v194, v194
  v_rcp_f32 v195, v195
  v_pk_fma_f32 v[192:193], v[80:81], v[192:193], v[80:81] neg_lo:[1,0,0] neg_hi:[1,0,0]
  v_pk_fma_f32 v[194:195], v[82:83], v[194:195], v[82:83] neg_lo:[1,0,0] neg_hi:[1,0,0]
  v_cvt_pk_bf16_f32 v200, v192, v193
  v_cvt_pk_bf16_f32 v201, v194, v195
  v_pk_mul_f32 v[196:197], v[84:85], s[90:91]
  v_pk_mul_f32 v[198:199], v[86:87], s[90:91]
  v_exp_f32 v196, v196
  v_exp_f32 v197, v197
  v_exp_f32 v198, v198
  v_exp_f32 v199, v199
  v_pk_fma_f32 v[196:197], v[196:197], v[14:15], v[14:15]
  v_pk_fma_f32 v[198:199], v[198:199], v[14:15], v[14:15]
  v_pk_fma_f32 v[196:197], v[196:197], v[196:197], 0.5 op_sel_hi:[1,1,0]
  v_pk_fma_f32 v[198:199], v[198:199], v[198:199], 0.5 op_sel_hi:[1,1,0]
  v_rcp_f32 v196, v196
  v_rcp_f32 v197, v197
  v_rcp_f32 v198, v198
  v_rcp_f32 v199, v199
  v_pk_fma_f32 v[196:197], v[84:85], v[196:197], v[84:85] neg_lo:[1,0,0] neg_hi:[1,0,0]
  v_pk_fma_f32 v[198:199], v[86:87], v[198:199], v[86:87] neg_lo:[1,0,0] neg_hi:[1,0,0]
  v_cvt_pk_bf16_f32 v202, v196, v197
  v_cvt_pk_bf16_f32 v203, v198, v199
  buffer_store_dwordx4 v[200:203], v48, s[36:39], s13 offen offset:0 sc1
  v_pk_mul_f32 v[192:193], v[88:89], s[90:91]
  v_pk_mul_f32 v[194:195], v[90:91], s[90:91]
  v_exp_f32 v192, v192
  v_exp_f32 v193, v193
  v_exp_f32 v194, v194
  v_exp_f32 v195, v195
  v_pk_fma_f32 v[192:193], v[192:193], v[14:15], v[14:15]
  v_pk_fma_f32 v[194:195], v[194:195], v[14:15], v[14:15]
  v_pk_fma_f32 v[192:193], v[192:193], v[192:193], 0.5 op_sel_hi:[1,1,0]
  v_pk_fma_f32 v[194:195], v[194:195], v[194:195], 0.5 op_sel_hi:[1,1,0]
  v_rcp_f32 v192, v192
  v_rcp_f32 v193, v193
  v_rcp_f32 v194, v194
  v_rcp_f32 v195, v195
  v_pk_fma_f32 v[192:193], v[88:89], v[192:193], v[88:89] neg_lo:[1,0,0] neg_hi:[1,0,0]
  v_pk_fma_f32 v[194:195], v[90:91], v[194:195], v[90:91] neg_lo:[1,0,0] neg_hi:[1,0,0]
  v_cvt_pk_bf16_f32 v204, v192, v193
  v_cvt_pk_bf16_f32 v205, v194, v195
  v_pk_mul_f32 v[196:197], v[92:93], s[90:91]
  v_pk_mul_f32 v[198:199], v[94:95], s[90:91]
  v_exp_f32 v196, v196
  v_exp_f32 v197, v197
  v_exp_f32 v198, v198
  v_exp_f32 v199, v199
  v_pk_fma_f32 v[196:197], v[196:197], v[14:15], v[14:15]
  v_pk_fma_f32 v[198:199], v[198:199], v[14:15], v[14:15]
  v_pk_fma_f32 v[196:197], v[196:197], v[196:197], 0.5 op_sel_hi:[1,1,0]
  v_pk_fma_f32 v[198:199], v[198:199], v[198:199], 0.5 op_sel_hi:[1,1,0]
  v_rcp_f32 v196, v196
  v_rcp_f32 v197, v197
  v_rcp_f32 v198, v198
  v_rcp_f32 v199, v199
  v_pk_fma_f32 v[196:197], v[92:93], v[196:197], v[92:93] neg_lo:[1,0,0] neg_hi:[1,0,0]
  v_pk_fma_f32 v[198:199], v[94:95], v[198:199], v[94:95] neg_lo:[1,0,0] neg_hi:[1,0,0]
  v_cvt_pk_bf16_f32 v206, v196, v197
  v_cvt_pk_bf16_f32 v207, v198, v199
  buffer_store_dwordx4 v[204:207], v48, s[36:39], s13 offen offset:1024 sc1
  s_waitcnt vmcnt(2)
  buffer_store_dwordx2 v[50:51], v52, s[36:39], s15 offen sc1
  s_waitcnt lgkmcnt(0)
  s_cmp_eq_u64 s[60:61], s[74:75]
  s_cselect_b64 s[62:63], s[62:63], 0
  s_cmp_eq_u64 s[62:63], s[74:75]
  s_cselect_b64 s[64:65], s[64:65], 0
  s_cmp_eq_u64 s[64:65], s[74:75]
  s_cselect_b64 s[66:67], s[66:67], 0
  s_cmp_eq_u64 s[66:67], s[74:75]
  s_cbranch_scc0 L_poll9
L_poll9_back:
  s_add_u32 s16, s89, 0
  buffer_load_dwordx4 a[0:3], v219, s[36:39], s16 offen offset:0 sc1
  buffer_load_dwordx4 a[4:7], v220, s[36:39], s16 offen offset:0 sc1
  buffer_load_dwordx4 a[8:11], v219, s[36:39], s16 offen offset:1024 sc1
  buffer_load_dwordx4 a[12:15], v220, s[36:39], s16 offen offset:1024 sc1
  buffer_load_dwordx4 a[16:19], v219, s[36:39], s16 offen offset:2048 sc1
  buffer_load_dwordx4 a[20:23], v220, s[36:39], s16 offen offset:2048 sc1
  buffer_load_dwordx4 a[24:27], v219, s[36:39], s16 offen offset:3072 sc1
  buffer_load_dwordx4 a[28:31], v220, s[36:39], s16 offen offset:3072 sc1
  ds_read_b64_tr_b16 a[112:113], v59 offset:0
  ds_read_b64_tr_b16 a[114:115], v59 offset:1024
  ds_read_b64_tr_b16 a[116:117], v60 offset:0
  ds_read_b64_tr_b16 a[118:119], v60 offset:1024
  ds_read_b64_tr_b16 a[120:121], v59 offset:2048
  ds_read_b64_tr_b16 a[122:123], v59 offset:3072
  ds_read_b64_tr_b16 a[124:125], v60 offset:2048
  ds_read_b64_tr_b16 a[126:127], v60 offset:3072
  ds_read_b64_tr_b16 a[128:129], v59 offset:4096
  ds_read_b64_tr_b16 a[130:131], v59 offset:5120
  ds_read_b64_tr_b16 a[132:133], v60 offset:4096
  ds_read_b64_tr_b16 a[134:135], v60 offset:5120
  ds_read_b64_tr_b16 a[136:137], v59 offset:6144
  ds_read_b64_tr_b16 a[138:139], v59 offset:7168
  ds_read_b64_tr_b16 a[140:141], v60 offset:6144
  ds_read_b64_tr_b16 a[142:143], v60 offset:7168
  ds_read_b64_tr_b16 a[144:145], v59 offset:8192
  ds_read_b64_tr_b16 a[146:147], v59 offset:9216
  ds_read_b64_tr_b16 a[148:149], v60 offset:8192
  ds_read_b64_tr_b16 a[150:151], v60 offset:9216
  ds_read_b64_tr_b16 a[152:153], v59 offset:10240
  ds_read_b64_tr_b16 a[154:155], v59 offset:11264
  ds_read_b64_tr_b16 a[156:157], v60 offset:10240
  ds_read_b64_tr_b16 a[158:159], v60 offset:11264
  s_waitcnt lgkmcnt(0)
  s_add_u32 s82, s100, 13107200
  s_waitcnt vmcnt(9)
  buffer_store_dwordx2 v[50:51], v52, s[36:39], s82 offen sc1
  s_mul_i32 s12, s56, 16448
  s_lshl_b32 s77, s86, 8
  s_add_u32 s12, s12, s77
  s_add_u32 s12, s12, 12058624
  v_lshrrev_b32 v5, 1, v1
  v_and_b32 v5, 28, v5
  s_add_u32 m0, s5, 0
  s_add_u32 s9, s19, 286720
  buffer_load_dwordx4 v53, s[40:43], s9 offen offset:0 lds
  buffer_load_dwordx4 v54, s[40:43], s9 offen offset:1024 lds
  buffer_load_dwordx4 v55, s[40:43], s9 offen offset:2048 lds
  buffer_load_dwordx4 v56, s[40:43], s9 offen offset:3072 lds
  s_sub_u32 s16, 16384, s89
  buffer_load_dwordx4 a[32:35], v219, s[36:39], s16 offen offset:0 sc1
  buffer_load_dwordx4 a[36:39], v220, s[36:39], s16 offen offset:0 sc1
  s_waitcnt vmcnt(13)
  v_mfma_f32_32x32x16_bf16 v[112:127], v[132:135], a[4:7], 0
  s_add_u32 m0, s5, 4096
  s_add_u32 s9, s19, 315392
  buffer_load_dwordx4 v53, s[40:43], s9 offen offset:0 lds
  buffer_load_dwordx4 v54, s[40:43], s9 offen offset:1024 lds
  v_mfma_f32_32x32x16_bf16 v[80:95], v[128:131], a[4:7], 0
  buffer_load_dwordx4 v55, s[40:43], s9 offen offset:2048 lds
  v_mfma_f32_32x32x16_bf16 v[96:111], v[132:135], a[0:3], 0
  buffer_load_dwordx4 v56, s[40:43], s9 offen offset:3072 lds
  buffer_load_dwordx4 a[40:43], v219, s[36:39], s16 offen offset:1024 sc1
  v_mfma_f32_32x32x16_bf16 v[64:79], v[128:131], a[0:3], 0
  buffer_load_dwordx4 a[44:47], v220, s[36:39], s16 offen offset:1024 sc1
  s_waitcnt vmcnt(17)
  v_mfma_f32_32x32x16_bf16 v[112:127], v[140:143], a[12:15], v[112:127]
  s_add_u32 m0, s5, 8192
  s_add_u32 s9, s18, 114688
  buffer_load_dwordx4 v53, s[40:43], s9 offen offset:0 lds
  buffer_load_dwordx4 v54, s[40:43], s9 offen offset:1024 lds
  v_mfma_f32_32x32x16_bf16 v[80:95], v[136:139], a[12:15], v[80:95]
  buffer_load_dwordx4 v55, s[40:43], s9 offen offset:2048 lds
  buffer_load_dwordx4 v56, s[40:43], s9 offen offset:3072 lds
  v_mfma_f32_32x32x16_bf16 v[96:111], v[140:143], a[8:11], v[96:111]
  buffer_load_dwordx4 a[48:51], v219, s[36:39], s16 offen offset:2048 sc1
  buffer_load_dwordx4 a[52:55], v220, s[36:39], s16 offen offset:2048 sc1
  v_mfma_f32_32x32x16_bf16 v[64:79], v[136:139], a[8:11], v[64:79]
  s_load_dwordx2 s[60:61], s[20:21], 0x50000 glc
  s_load_dwordx2 s[62:63], s[20:21], 0x50080 glc
  s_load_dwordx2 s[64:65], s[20:21], 0x50100 glc
  s_load_dwordx2 s[66:67], s[20:21], 0x50180 glc
  s_waitcnt vmcnt(21)
  v_mfma_f32_32x32x16_bf16 v[112:127], v[148:151], a[20:23], v[112:127]
  s_add_u32 m0, s5, 12288
  s_add_u32 s9, s18, 143360
  buffer_load_dwordx4 v53, s[40:43], s9 offen offset:0 lds
  v_mfma_f32_32x32x16_bf16 v[80:95], v[144:147], a[20:23], v[80:95]
  buffer_load_dwordx4 v54, s[40:43], s9 offen offset:1024 lds
  buffer_load_dwordx4 a[56:59], v219, s[36:39], s16 offen offset:3072 sc1
  v_mfma_f32_32x32x16_bf16 v[96:111], v[148:151], a[16:19], v[96:111]
  buffer_load_dwordx4 a[60:63], v220, s[36:39], s16 offen offset:3072 sc1
  v_mfma_f32_32x32x16_bf16 v[64:79], v[144:147], a[16:19], v[64:79]
  s_mov_b32 s17, 12648448
  buffer_load_dwordx2 v[44:45], v57, s[36:39], s17 offen sc1
  s_waitcnt vmcnt(24)
  v_mfma_f32_32x32x16_bf16 v[112:127], v[156:159], a[28:31], v[112:127]
  s_waitcnt lgkmcnt(0)
  s_cmp_eq_u64 s[60:61], s[74:75]
  s_cselect_b64 s[62:63], s[62:63], 0
  s_cmp_eq_u64 s[62:63], s[74:75]
  s_cselect_b64 s[64:65], s[64:65], 0
  s_cmp_eq_u64 s[64:65], s[74:75]
  s_cselect_b64 s[66:67], s[66:67], 0
  s_cmp_eq_u64 s[66:67], s[74:75]
  s_cbranch_scc0 L_poll10
L_poll10_back:
  v_mfma_f32_32x32x16_bf16 v[80:95], v[152:155], a[28:31], v[80:95]
  s_add_u32 s16, s89, 4096
  buffer_load_dwordx4 a[0:3], v219, s[36:39], s16 offen offset:0 sc1
  v_mfma_f32_32x32x16_bf16 v[96:111], v[156:159], a[24:27], v[96:111]
  buffer_load_dwordx4 a[4:7], v220, s[36:39], s16 offen offset:0 sc1
  v_mfma_f32_32x32x16_bf16 v[64:79], v[152:155], a[24:27], v[64:79]
  s_waitcnt vmcnt(19)
  v_mfma_f32_32x32x16_bf16 v[112:127], v[20:23], a[36:39], v[112:127]
  buffer_load_dwordx4 a[8:11], v219, s[36:39], s16 offen offset:1024 sc1
  v_mfma_f32_32x32x16_bf16 v[80:95], v[16:19], a[36:39], v[80:95]
  v_mfma_f32_32x32x16_bf16 v[96:111], v[20:23], a[32:35], v[96:111]
  buffer_load_dwordx4 a[12:15], v220, s[36:39], s16 offen offset:1024 sc1
  v_mfma_f32_32x32x16_bf16 v[64:79], v[16:19], a[32:35], v[64:79]
  s_waitcnt vmcnt(15)
  v_mfma_f32_32x32x16_bf16 v[112:127], v[228:231], a[44:47], v[112:127]
  buffer_load_dwordx4 a[16:19], v219, s[36:39], s16 offen offset:2048 sc1
  v_mfma_f32_32x32x16_bf16 v[80:95], v[224:227], a[44:47], v[80:95]
  v_mfma_f32_32x32x16_bf16 v[96:111], v[228:231], a[40:43], v[96:111]
  buffer_load_dwordx4 a[20:23], v220, s[36:39], s16 offen offset:2048 sc1
  v_mfma_f32_32x32x16_bf16 v[64:79], v[224:227], a[40:43], v[64:79]
  s_waitcnt vmcnt(11)
  v_mfma_f32_32x32x16_bf16 v[112:127], a[116:119], a[52:55], v[112:127]
  buffer_load_dwordx4 a[24:27], v219, s[36:39], s16 offen offset:3072 sc1
  buffer_load_dwordx4 a[28:31], v220, s[36:39], s16 offen offset:3072 sc1
  v_mfma_f32_32x32x16_bf16 v[80:95], a[112:115], a[52:55], v[80:95]
  s_load_dwordx2 s[60:61], s[20:21], 0x80000 glc
  s_load_dwordx2 s[62:63], s[20:21], 0x80080 glc
  s_load_dwordx2 s[64:65], s[20:21], 0x80100 glc
  s_load_dwordx2 s[66:67], s[20:21], 0x80180 glc
  s_waitcnt vmcnt(8)
  v_cmp_ne_u64 vcc, s[74:75], v[44:45]
s_cbranch_vccnz L_poll11
L_poll11_back:
  buffer_load_dwordx4 v[192:195], v4, s[36:39], s10 offen offset:0 sc1
  v_mfma_f32_32x32x16_bf16 v[96:111], a[116:119], a[48:51], v[96:111]
  buffer_load_dwordx4 v[196:199], v4, s[36:39], s10 offen offset:1024 sc1
  buffer_load_dwordx4 v[200:203], v4, s[36:39], s10 offen offset:2048 sc1
  v_mfma_f32_32x32x16_bf16 v[64:79], a[112:115], a[48:51], v[64:79]
  buffer_load_dwordx4 v[204:207], v4, s[36:39], s10 offen offset:3072 sc1
  v_mfma_f32_32x32x16_bf16 v[112:127], a[124:127], a[60:63], v[112:127]
  s_sub_u32 s16, 20480, s89
  buffer_load_dwordx4 a[32:35], v219, s[36:39], s16 offen offset:0 sc1
  v_mfma_f32_32x32x16_bf16 v[80:95], a[120:123], a[60:63], v[80:95]
  v_mfma_f32_32x32x16_bf16 v[96:111], a[124:127], a[56:59], v[96:111]
  buffer_load_dwordx4 a[36:39], v220, s[36:39], s16 offen offset:0 sc1
  v_mfma_f32_32x32x16_bf16 v[64:79], a[120:123], a[56:59], v[64:79]
  s_waitcnt vmcnt(12)
  v_mfma_f32_32x32x16_bf16 v[112:127], a[132:135], a[4:7], v[112:127]
  s_add_u32 m0, s4, 0
  s_add_u32 s9, s18, 157696
  buffer_load_dwordx4 v53, s[40:43], s9 offen offset:0 lds
  buffer_load_dwordx4 v54, s[40:43], s9 offen offset:1024 lds
  v_mfma_f32_32x32x16_bf16 v[80:95], a[128:131], a[4:7], v[80:95]
  s_add_u32 m0, s4, 2048
  s_add_u32 s9, s19, 344064
  buffer_load_dwordx4 v53, s[40:43], s9 offen offset:0 lds
  v_mfma_f32_32x32x16_bf16 v[96:111], a[132:135], a[0:3], v[96:111]
  buffer_load_dwordx4 v54, s[40:43], s9 offen offset:1024 lds
  buffer_load_dwordx4 a[40:43], v219, s[36:39], s16 offen offset:1024 sc1
  v_mfma_f32_32x32x16_bf16 v[64:79], a[128:131], a[0:3], v[64:79]
  buffer_load_dwordx4 a[44:47], v220, s[36:39], s16 offen offset:1024 sc1
  s_waitcnt vmcnt(11)
  v_mfma_f32_32x32x16_bf16 v[128:143], v[192:195], v[160:163], 0
  s_waitcnt vmcnt(10)
  v_mfma_f32_32x32x16_bf16 v[128:143], v[196:199], v[164:167], v[128:143]
  s_waitcnt vmcnt(9)
  v_mfma_f32_32x32x16_bf16 v[128:143], v[200:203], v[168:171], v[128:143]
  s_waitcnt vmcnt(8)
  v_mfma_f32_32x32x16_bf16 v[128:143], v[204:207], v[172:175], v[128:143]
  v_mfma_f32_32x32x16_bf16 v[144:159], v[192:195], v[176:179], 0
  v_mfma_f32_32x32x16_bf16 v[144:159], v[196:199], v[180:183], v[144:159]
  v_mfma_f32_32x32x16_bf16 v[144:159], v[200:203], v[184:187], v[144:159]
  v_mfma_f32_32x32x16_bf16 v[144:159], v[204:207], v[188:191], v[144:159]
  s_nop 7
  v_add_f32 v208, 0x358637bd, v140
  v_rcp_f32 v208, v208
  s_nop 0
  v_mul_f32 v208, v208, v40
  v_mov_b32 v209, v208
  s_nop 1
  v_permlane32_swap_b32 v208, v209
  v_pk_mul_f32 v[128:129], v[128:129], v[208:209] op_sel:[0,1] op_sel_hi:[1,1]
  v_pk_mul_f32 v[130:131], v[130:131], v[208:209] op_sel:[0,1] op_sel_hi:[1,1]
  v_pk_mul_f32 v[132:133], v[132:133], v[208:209] op_sel:[0,1] op_sel_hi:[1,1]
  v_pk_mul_f32 v[134:135], v[134:135], v[208:209] op_sel:[0,1] op_sel_hi:[1,1]
  v_pk_mul_f32 v[136:137], v[136:137], v[208:209] op_sel:[0,1] op_sel_hi:[1,1]
  v_pk_mul_f32 v[138:139], v[138:139], v[208:209] op_sel:[0,1] op_sel_hi:[1,1]
  v_pk_mul_f32 v[140:141], v[140:141], v[208:209] op_sel:[0,1] op_sel_hi:[1,1]
  v_pk_mul_f32 v[142:143], v[142:143], v[208:209] op_sel:[0,1] op_sel_hi:[1,1]
  v_cvt_pk_bf16_f32 v160, v128, v129
  v_cvt_pk_bf16_f32 v161, v130, v131
  v_cvt_pk_bf16_f32 v162, v132, v133
  v_cvt_pk_bf16_f32 v163, v134, v135
  v_cvt_pk_bf16_f32 v164, v136, v137
  v_cvt_pk_bf16_f32 v165, v138, v139
  v_cvt_pk_bf16_f32 v166, v140, v141
  v_cvt_pk_bf16_f32 v167, v142, v143
  v_cndmask_b32 v166, v166, 0, s[92:93]
  v_cndmask_b32 v167, v167, 0, s[92:93]
  buffer_store_dwordx4 v[160:163], v39, s[36:39], s11 offen offset:0 sc1
  buffer_store_dwordx4 v[164:167], v39, s[36:39], s11 offen offset:1024 sc1
  v_add_f32 v208, 0x358637bd, v156
  v_rcp_f32 v208, v208
  s_nop 0
  v_mul_f32 v208, v208, v41
  v_mov_b32 v209, v208
  s_nop 1
  v_permlane32_swap_b32 v208, v209
  v_pk_mul_f32 v[144:145], v[144:145], v[208:209] op_sel:[0,1] op_sel_hi:[1,1]
  v_pk_mul_f32 v[146:147], v[146:147], v[208:209] op_sel:[0,1] op_sel_hi:[1,1]
  v_pk_mul_f32 v[148:149], v[148:149], v[208:209] op_sel:[0,1] op_sel_hi:[1,1]
  v_pk_mul_f32 v[150:151], v[150:151], v[208:209] op_sel:[0,1] op_sel_hi:[1,1]
  v_pk_mul_f32 v[152:153], v[152:153], v[208:209] op_sel:[0,1] op_sel_hi:[1,1]
  v_pk_mul_f32 v[154:155], v[154:155], v[208:209] op_sel:[0,1] op_sel_hi:[1,1]
  v_pk_mul_f32 v[156:157], v[156:157], v[208:209] op_sel:[0,1] op_sel_hi:[1,1]
  v_pk_mul_f32 v[158:159], v[158:159], v[208:209] op_sel:[0,1] op_sel_hi:[1,1]
  v_cvt_pk_bf16_f32 v168, v144, v145
  v_cvt_pk_bf16_f32 v169, v146, v147
  v_cvt_pk_bf16_f32 v170, v148, v149
  v_cvt_pk_bf16_f32 v171, v150, v151
  v_cvt_pk_bf16_f32 v172, v152, v153
  v_cvt_pk_bf16_f32 v173, v154, v155
  v_cvt_pk_bf16_f32 v174, v156, v157
  v_cvt_pk_bf16_f32 v175, v158, v159
  v_cndmask_b32 v174, v174, 0, s[92:93]
  v_cndmask_b32 v175, v175, 0, s[92:93]
  buffer_store_dwordx4 v[168:171], v48, s[36:39], s11 offen offset:0 sc1
  buffer_store_dwordx4 v[172:175], v48, s[36:39], s11 offen offset:1024 sc1
  v_mfma_f32_32x32x16_bf16 v[112:127], a[140:143], a[12:15], v[112:127]
  buffer_load_dwordx4 a[48:51], v219, s[36:39], s16 offen offset:2048 sc1
  v_mfma_f32_32x32x16_bf16 v[80:95], a[136:139], a[12:15], v[80:95]
  v_mfma_f32_32x32x16_bf16 v[96:111], a[140:143], a[8:11], v[96:111]
  buffer_load_dwordx4 a[52:55], v220, s[36:39], s16 offen offset:2048 sc1
  v_mfma_f32_32x32x16_bf16 v[64:79], a[136:139], a[8:11], v[64:79]
  v_mfma_f32_32x32x16_bf16 v[112:127], a[148:151], a[20:23], v[112:127]
  s_add_u32 m0, s4, 4096
  s_add_u32 s9, s19, 358400
  buffer_load_dwordx4 v53, s[40:43], s9 offen offset:0 lds
  buffer_load_dwordx4 v54, s[40:43], s9 offen offset:1024 lds
  buffer_load_dwordx4 v55, s[40:43], s9 offen offset:2048 lds
  v_mfma_f32_32x32x16_bf16 v[80:95], a[144:147], a[20:23], v[80:95]
  buffer_load_dwordx4 v56, s[40:43], s9 offen offset:3072 lds
  buffer_load_dwordx4 a[56:59], v219, s[36:39], s16 offen offset:3072 sc1
  buffer_load_dwordx4 a[60:63], v220, s[36:39], s16 offen offset:3072 sc1
  v_mfma_f32_32x32x16_bf16 v[96:111], a[148:151], a[16:19], v[96:111]
  ds_read_b64_tr_b16 a[64:65], v61 offset:0
  ds_read_b64_tr_b16 a[66:67], v61 offset:1024
  ds_read_b64_tr_b16 a[68:69], v62 offset:0
  ds_read_b64_tr_b16 a[70:71], v62 offset:1024
  ds_read_b64_tr_b16 a[72:73], v61 offset:2048
  ds_read_b64_tr_b16 a[74:75], v61 offset:3072
  ds_read_b64_tr_b16 a[76:77], v62 offset:2048
  ds_read_b64_tr_b16 a[78:79], v62 offset:3072
  ds_read_b64_tr_b16 a[80:81], v61 offset:4096
  ds_read_b64_tr_b16 a[82:83], v61 offset:5120
  ds_read_b64_tr_b16 a[84:85], v62 offset:4096
  v_mfma_f32_32x32x16_bf16 v[64:79], a[144:147], a[16:19], v[64:79]
  ds_read_b64_tr_b16 a[86:87], v62 offset:5120
  ds_read_b64_tr_b16 a[88:89], v61 offset:6144
  ds_read_b64_tr_b16 a[90:91], v61 offset:7168
  ds_read_b64_tr_b16 a[92:93], v62 offset:6144
  ds_read_b64_tr_b16 a[94:95], v62 offset:7168
  ds_read_b64_tr_b16 a[96:97], v61 offset:8192
  ds_read_b64_tr_b16 a[98:99], v61 offset:9216
  ds_read_b64_tr_b16 a[100:101], v62 offset:8192
  ds_read_b64_tr_b16 a[102:103], v62 offset:9216
  ds_read_b64_tr_b16 a[104:105], v61 offset:10240
  ds_read_b64_tr_b16 a[106:107], v61 offset:11264
  ds_read_b64_tr_b16 a[108:109], v62 offset:10240
  ds_read_b64_tr_b16 a[110:111], v62 offset:11264
  v_mfma_f32_32x32x16_bf16 v[112:127], a[156:159], a[28:31], v[112:127]
  s_waitcnt lgkmcnt(0)
  s_cmp_eq_u64 s[60:61], s[74:75]
  s_cselect_b64 s[62:63], s[62:63], 0
  s_cmp_eq_u64 s[62:63], s[74:75]
  s_cselect_b64 s[64:65], s[64:65], 0
  s_cmp_eq_u64 s[64:65], s[74:75]
  s_cselect_b64 s[66:67], s[66:67], 0
  s_cmp_eq_u64 s[66:67], s[74:75]
  s_cbranch_scc0 L_poll12
L_poll12_back:
  s_add_u32 s16, s89, 8192
  v_mfma_f32_32x32x16_bf16 v[80:95], a[152:155], a[28:31], v[80:95]
  buffer_load_dwordx4 a[0:3], v219, s[36:39], s16 offen offset:0 sc1
  v_mfma_f32_32x32x16_bf16 v[96:111], a[156:159], a[24:27], v[96:111]
  buffer_load_dwordx4 a[4:7], v220, s[36:39], s16 offen offset:0 sc1
  v_mfma_f32_32x32x16_bf16 v[64:79], a[152:155], a[24:27], v[64:79]
  s_load_dwordx2 s[60:61], s[20:21], 0x90000 glc
  s_load_dwordx2 s[62:63], s[20:21], 0x90080 glc
  s_load_dwordx2 s[64:65], s[20:21], 0x90100 glc
  s_load_dwordx2 s[66:67], s[20:21], 0x90180 glc
  s_waitcnt vmcnt(20)
  v_mfma_f32_32x32x16_bf16 v[112:127], a[68:71], a[36:39], v[112:127]
  s_add_u32 m0, s4, 8192
  s_add_u32 s9, s19, 387072
  buffer_load_dwordx4 v53, s[40:43], s9 offen offset:0 lds
  buffer_load_dwordx4 v54, s[40:43], s9 offen offset:1024 lds
  v_mfma_f32_32x32x16_bf16 v[80:95], a[64:67], a[36:39], v[80:95]
  s_add_u32 m0, s4, 10240
  s_add_u32 s9, s7, 172032
  buffer_load_dwordx4 v53, s[40:43], s9 offen offset:0 lds
  buffer_load_dwordx4 v54, s[40:43], s9 offen offset:1024 lds
  v_mfma_f32_32x32x16_bf16 v[96:111], a[68:71], a[32:35], v[96:111]
  buffer_load_dwordx4 a[8:11], v219, s[36:39], s16 offen offset:1024 sc1
  buffer_load_dwordx4 a[12:15], v220, s[36:39], s16 offen offset:1024 sc1
  v_mfma_f32_32x32x16_bf16 v[64:79], a[64:67], a[32:35], v[64:79]
  s_add_u32 s82, s100, 12845056
  s_waitcnt vmcnt(16)
  buffer_store_dwordx2 v[50:51], v52, s[36:39], s82 offen sc1
  v_mfma_f32_32x32x16_bf16 v[112:127], a[76:79], a[44:47], v[112:127]
  buffer_load_dwordx4 a[16:19], v219, s[36:39], s16 offen offset:2048 sc1
  v_mfma_f32_32x32x16_bf16 v[80:95], a[72:75], a[44:47], v[80:95]
  v_mfma_f32_32x32x16_bf16 v[96:111], a[76:79], a[40:43], v[96:111]
  buffer_load_dwordx4 a[20:23], v220, s[36:39], s16 offen offset:2048 sc1
  v_mfma_f32_32x32x16_bf16 v[64:79], a[72:75], a[40:43], v[64:79]
  s_waitcnt vmcnt(17)
  v_mfma_f32_32x32x16_bf16 v[112:127], a[84:87], a[52:55], v[112:127]
  buffer_load_dwordx4 a[24:27], v219, s[36:39], s16 offen offset:3072 sc1
  v_mfma_f32_32x32x16_bf16 v[80:95], a[80:83], a[52:55], v[80:95]
  v_mfma_f32_32x32x16_bf16 v[96:111], a[84:87], a[48:51], v[96:111]
  buffer_load_dwordx4 a[28:31], v220, s[36:39], s16 offen offset:3072 sc1
  v_mfma_f32_32x32x16_bf16 v[64:79], a[80:83], a[48:51], v[64:79]
  s_waitcnt vmcnt(13)
  v_mfma_f32_32x32x16_bf16 v[112:127], a[92:95], a[60:63], v[112:127]
  s_add_u32 m0, s5, 0
  s_add_u32 s9, s7, 186368
  buffer_load_dwordx4 v53, s[40:43], s9 offen offset:0 lds
  buffer_load_dwordx4 v54, s[40:43], s9 offen offset:1024 lds
  v_mfma_f32_32x32x16_bf16 v[80:95], a[88:91], a[60:63], v[80:95]
  buffer_load_dwordx4 v55, s[40:43], s9 offen offset:2048 lds
  buffer_load_dwordx4 v56, s[40:43], s9 offen offset:3072 lds
  s_add_u32 m0, s5, 4096
  v_mfma_f32_32x32x16_bf16 v[96:111], a[92:95], a[56:59], v[96:111]
  s_add_u32 s9, s7, 215040
  buffer_load_dwordx4 v53, s[40:43], s9 offen offset:0 lds
  buffer_load_dwordx4 v54, s[40:43], s9 offen offset:1024 lds
  v_mfma_f32_32x32x16_bf16 v[64:79], a[88:91], a[56:59], v[64:79]
  s_sub_u32 s16, 24576, s89
  buffer_load_dwordx4 a[32:35], v219, s[36:39], s16 offen offset:0 sc1
  buffer_load_dwordx4 a[36:39], v220, s[36:39], s16 offen offset:0 sc1
  s_waitcnt vmcnt(19)
  v_mfma_f32_32x32x16_bf16 v[112:127], a[100:103], a[4:7], v[112:127]
  buffer_load_dwordx4 a[40:43], v219, s[36:39], s16 offen offset:1024 sc1
  buffer_load_dwordx4 a[44:47], v220, s[36:39], s16 offen offset:1024 sc1
  v_mfma_f32_32x32x16_bf16 v[80:95], a[96:99], a[4:7], v[80:95]
  ds_read_b64_tr_b16 a[160:161], v61 offset:12288
  ds_read_b64_tr_b16 a[162:163], v61 offset:13312
  ds_read_b64_tr_b16 a[164:165], v62 offset:12288
  ds_read_b64_tr_b16 a[166:167], v62 offset:13312
  ds_read_b64_tr_b16 a[168:169], v59 offset:0
  ds_read_b64_tr_b16 a[170:171], v59 offset:1024
  ds_read_b64_tr_b16 a[172:173], v60 offset:0
  ds_read_b64_tr_b16 a[174:175], v60 offset:1024
  v_mfma_f32_32x32x16_bf16 v[96:111], a[100:103], a[0:3], v[96:111]
  ds_read_b64_tr_b16 a[176:177], v59 offset:2048
  ds_read_b64_tr_b16 a[178:179], v59 offset:3072
  ds_read_b64_tr_b16 a[180:181], v60 offset:2048
  ds_read_b64_tr_b16 a[182:183], v60 offset:3072
  ds_read_b64_tr_b16 a[184:185], v59 offset:4096
  ds_read_b64_tr_b16 a[186:187], v59 offset:5120
  ds_read_b64_tr_b16 a[188:189], v60 offset:4096
  ds_read_b64_tr_b16 a[190:191], v60 offset:5120
  v_mfma_f32_32x32x16_bf16 v[64:79], a[96:99], a[0:3], v[64:79]
  ds_read_b64_tr_b16 a[192:193], v59 offset:6144
  ds_read_b64_tr_b16 a[194:195], v59 offset:7168
  ds_read_b64_tr_b16 a[196:197], v60 offset:6144
  ds_read_b64_tr_b16 a[198:199], v60 offset:7168
  s_waitcnt vmcnt(17)
  ds_read_b64_tr_b16 a[200:201], v59 offset:8192
  ds_read_b64_tr_b16 a[202:203], v59 offset:9216
  ds_read_b64_tr_b16 a[204:205], v60 offset:8192
  ds_read_b64_tr_b16 a[206:207], v60 offset:9216
  s_waitcnt vmcnt(15)
  v_mfma_f32_32x32x16_bf16 v[112:127], a[108:111], a[12:15], v[112:127]
  s_waitcnt lgkmcnt(0)
  buffer_load_dwordx4 a[48:51], v219, s[36:39], s16 offen offset:2048 sc1
  v_mfma_f32_32x32x16_bf16 v[80:95], a[104:107], a[12:15], v[80:95]
  v_mfma_f32_32x32x16_bf16 v[96:111], a[108:111], a[8:11], v[96:111]
  buffer_load_dwordx4 a[52:55], v220, s[36:39], s16 offen offset:2048 sc1
  v_mfma_f32_32x32x16_bf16 v[64:79], a[104:107], a[8:11], v[64:79]
  s_waitcnt vmcnt(14)
  v_mfma_f32_32x32x16_bf16 v[112:127], a[164:167], a[20:23], v[112:127]
  buffer_load_dwordx4 a[56:59], v219, s[36:39], s16 offen offset:3072 sc1
  v_mfma_f32_32x32x16_bf16 v[80:95], a[160:163], a[20:23], v[80:95]
  v_mfma_f32_32x32x16_bf16 v[96:111], a[164:167], a[16:19], v[96:111]
  buffer_load_dwordx4 a[60:63], v220, s[36:39], s16 offen offset:3072 sc1
  v_mfma_f32_32x32x16_bf16 v[64:79], a[160:163], a[16:19], v[64:79]
  s_waitcnt vmcnt(14)
  v_mfma_f32_32x32x16_bf16 v[112:127], a[172:175], a[28:31], v[112:127]
  s_cmp_eq_u64 s[60:61], s[74:75]
  s_cselect_b64 s[62:63], s[62:63], 0
  s_cmp_eq_u64 s[62:63], s[74:75]
  s_cselect_b64 s[64:65], s[64:65], 0
  s_cmp_eq_u64 s[64:65], s[74:75]
  s_cselect_b64 s[66:67], s[66:67], 0
  s_cmp_eq_u64 s[66:67], s[74:75]
  s_cbranch_scc0 L_poll13
L_poll13_back:
  v_mfma_f32_32x32x16_bf16 v[80:95], a[168:171], a[28:31], v[80:95]
  s_movk_i32 s16, 12288
  buffer_load_dwordx4 a[0:3], v219, s[36:39], s16 offen offset:0 sc1
  v_mfma_f32_32x32x16_bf16 v[96:111], a[172:175], a[24:27], v[96:111]
  buffer_load_dwordx4 a[4:7], v220, s[36:39], s16 offen offset:0 sc1
  v_mfma_f32_32x32x16_bf16 v[64:79], a[168:171], a[24:27], v[64:79]
  s_waitcnt vmcnt(8)
  v_mfma_f32_32x32x16_bf16 v[112:127], a[180:183], a[36:39], v[112:127]
  buffer_load_dwordx4 a[8:11], v219, s[36:39], s16 offen offset:1024 sc1
  buffer_load_dwordx4 a[12:15], v220, s[36:39], s16 offen offset:1024 sc1
  v_mfma_f32_32x32x16_bf16 v[80:95], a[176:179], a[36:39], v[80:95]
  s_load_dwordx2 s[60:61], s[20:21], 0x40000 glc
  v_mfma_f32_32x32x16_bf16 v[96:111], a[180:183], a[32:35], v[96:111]
  s_load_dwordx2 s[62:63], s[20:21], 0x40080 glc
  s_load_dwordx2 s[64:65], s[20:21], 0x40100 glc
  s_load_dwordx2 s[66:67], s[20:21], 0x40180 glc
  v_lshlrev_b32 v12, 8, v3
  v_and_b32 v13, 15, v1
  v_mfma_f32_32x32x16_bf16 v[64:79], a[176:179], a[32:35], v[64:79]
  v_xor_b32 v13, v13, v2
  v_lshl_add_u32 v12, v13, 4, v12
  v_add_u32 v10, s5, v12
  v_add_u32 v11, s4, v12
  s_waitcnt vmcnt(8)
  v_mfma_f32_32x32x16_bf16 v[112:127], a[188:191], a[44:47], v[112:127]
  buffer_load_dwordx4 a[16:19], v219, s[36:39], s16 offen offset:2048 sc1
  v_mfma_f32_32x32x16_bf16 v[80:95], a[184:187], a[44:47], v[80:95]
  buffer_load_dwordx4 a[20:23], v220, s[36:39], s16 offen offset:2048 sc1
  v_mfma_f32_32x32x16_bf16 v[96:111], a[188:191], a[40:43], v[96:111]
  s_mul_i32 s76, s84, -2048
  s_add_u32 s76, s76, 14336
  s_mul_i32 s77, s84, 114688
  v_mfma_f32_32x32x16_bf16 v[64:79], a[184:187], a[40:43], v[64:79]
  s_lshl_b32 s78, s85, 12
  s_add_u32 s77, s77, s78
  v_lshrrev_b32 v14, 3, v1
  s_waitcnt vmcnt(8)
  v_mfma_f32_32x32x16_bf16 v[112:127], a[196:199], a[52:55], v[112:127]
  buffer_load_dwordx4 a[24:27], v219, s[36:39], s16 offen offset:3072 sc1
  buffer_load_dwordx4 a[28:31], v220, s[36:39], s16 offen offset:3072 sc1
  ds_read_b64_tr_b16 a[64:65], v59 offset:10240
  v_mfma_f32_32x32x16_bf16 v[80:95], a[192:195], a[52:55], v[80:95]
  ds_read_b64_tr_b16 a[66:67], v59 offset:11264
  ds_read_b64_tr_b16 a[68:69], v60 offset:10240
  ds_read_b64_tr_b16 a[70:71], v60 offset:11264
  ds_read_b64_tr_b16 a[72:73], v61 offset:0
  ds_read_b64_tr_b16 a[74:75], v61 offset:1024
  ds_read_b64_tr_b16 a[76:77], v62 offset:0
  ds_read_b64_tr_b16 a[78:79], v62 offset:1024
  ds_read_b64_tr_b16 a[80:81], v61 offset:2048
  ds_read_b64_tr_b16 a[82:83], v61 offset:3072
  ds_read_b64_tr_b16 a[84:85], v62 offset:2048
  v_mfma_f32_32x32x16_bf16 v[96:111], a[196:199], a[48:51], v[96:111]
  ds_read_b64_tr_b16 a[86:87], v62 offset:3072
  ds_read_b64_tr_b16 a[88:89], v61 offset:4096
  ds_read_b64_tr_b16 a[90:91], v61 offset:5120
  ds_read_b64_tr_b16 a[92:93], v62 offset:4096
  ds_read_b64_tr_b16 a[94:95], v62 offset:5120
  ds_read_b64_tr_b16 a[96:97], v63 offset:28672
  ds_read_b64_tr_b16 a[98:99], v63 offset:29696
  ds_read_b64_tr_b16 a[100:101], v216 offset:28672
  ds_read_b64_tr_b16 a[102:103], v216 offset:29696
  ds_read_b64_tr_b16 a[104:105], v63 offset:30720
  v_mfma_f32_32x32x16_bf16 v[64:79], a[192:195], a[48:51], v[64:79]
  ds_read_b64_tr_b16 a[106:107], v217 offset:31744
  ds_read_b64_tr_b16 a[108:109], v216 offset:30720
  ds_read_b64_tr_b16 a[110:111], v218 offset:31744
  v_lshlrev_b32 v13, 8, v14
  v_add_u32 v13, s77, v13
  v_and_b32 v12, 7, v1
  v_lshlrev_b32 v12, 1, v12
  v_xor_b32 v12, v12, v14
  v_lshl_add_u32 v232, v12, 4, v13
  v_xor_b32 v233, 16, v232
  s_waitcnt vmcnt(8)
  v_mfma_f32_32x32x16_bf16 v[112:127], a[204:207], a[60:63], v[112:127]
  s_waitcnt lgkmcnt(0)
  s_cmp_eq_u64 s[60:61], s[74:75]
  s_cselect_b64 s[62:63], s[62:63], 0
  s_cmp_eq_u64 s[62:63], s[74:75]
  s_cselect_b64 s[64:65], s[64:65], 0
  s_cmp_eq_u64 s[64:65], s[74:75]
  s_cselect_b64 s[66:67], s[66:67], 0
  s_cmp_eq_u64 s[66:67], s[74:75]
  s_cbranch_scc0 L_poll14
L_poll14_back:
  buffer_load_dword v8, v5, s[36:39], s12 offen sc1
  v_mfma_f32_32x32x16_bf16 v[80:95], a[200:203], a[60:63], v[80:95]
  buffer_load_dword v9, v5, s[36:39], s12 offen offset:32 sc1
  s_mul_i32 s16, s56, -20480
  s_add_u32 s16, s16, 114688
  s_lshr_b32 s89, s89, 2
  s_add_u32 s16, s16, s89
  v_mfma_f32_32x32x16_bf16 v[96:111], a[204:207], a[56:59], v[96:111]
  s_lshl_b32 s89, s89, 1
  buffer_load_dwordx4 a[32:35], v219, s[36:39], s16 offen offset:0 sc1
  buffer_load_dwordx4 a[36:39], v220, s[36:39], s16 offen offset:0 sc1
  v_mfma_f32_32x32x16_bf16 v[64:79], a[200:203], a[56:59], v[64:79]
  v_xor_b32 v234, 128, v232
  v_xor_b32 v235, 128, v233
  v_add_u32 v236, s76, v232
  v_add_u32 v237, s76, v233
  v_add_u32 v238, s76, v234
  v_add_u32 v239, s76, v235
  s_waitcnt vmcnt(10)
  v_mfma_f32_32x32x16_bf16 v[112:127], a[68:71], a[4:7], v[112:127]
  buffer_load_dwordx4 a[40:43], v219, s[36:39], s16 offen offset:1024 sc1
  v_mfma_f32_32x32x16_bf16 v[80:95], a[64:67], a[4:7], v[80:95]
  buffer_load_dwordx4 a[44:47], v220, s[36:39], s16 offen offset:1024 sc1
  v_mfma_f32_32x32x16_bf16 v[96:111], a[68:71], a[0:3], v[96:111]
  v_add_u32 v240, s76, v236
  v_add_u32 v241, s76, v237
  v_add_u32 v242, s76, v238
  v_mfma_f32_32x32x16_bf16 v[64:79], a[64:67], a[0:3], v[64:79]
  v_add_u32 v243, s76, v239
  v_add_u32 v244, s76, v240
  v_add_u32 v245, s76, v241
  v_add_u32 v246, s76, v242
  s_waitcnt vmcnt(10)
  v_mfma_f32_32x32x16_bf16 v[112:127], a[76:79], a[12:15], v[112:127]
  buffer_load_dwordx4 a[48:51], v219, s[36:39], s16 offen offset:2048 sc1
  v_mfma_f32_32x32x16_bf16 v[80:95], a[72:75], a[12:15], v[80:95]
  buffer_load_dwordx4 a[52:55], v220, s[36:39], s16 offen offset:2048 sc1
  v_mfma_f32_32x32x16_bf16 v[96:111], a[76:79], a[8:11], v[96:111]
  v_add_u32 v247, s76, v243
  s_mov_b32 s52, s22
  s_and_b32 s53, s23, 0xffff
  v_mfma_f32_32x32x16_bf16 v[64:79], a[72:75], a[8:11], v[64:79]
  s_mov_b32 s54, 1835008
  s_mov_b32 s55, 0x20000
  s_lshl2_add_u32 s76, s86, s56
  s_waitcnt vmcnt(10)
  v_mfma_f32_32x32x16_bf16 v[112:127], a[84:87], a[20:23], v[112:127]
  buffer_load_dwordx4 a[56:59], v219, s[36:39], s16 offen offset:3072 sc1
  v_mfma_f32_32x32x16_bf16 v[80:95], a[80:83], a[20:23], v[80:95]
  buffer_load_dwordx4 a[60:63], v220, s[36:39], s16 offen offset:3072 sc1
  v_mfma_f32_32x32x16_bf16 v[96:111], a[84:87], a[16:19], v[96:111]
  s_mul_i32 s76, s76, 14336
  s_lshl_b32 s77, s87, 7
  s_add_u32 s76, s76, s77
  v_mfma_f32_32x32x16_bf16 v[64:79], a[80:83], a[16:19], v[64:79]
  s_add_u32 s77, s76, 7168
  v_mul_u32_u24 v14, 896, v14
  v_and_b32 v12, 7, v1
  v_lshl_add_u32 v14, v12, 4, v14
  s_waitcnt vmcnt(10)
  v_mfma_f32_32x32x16_bf16 v[112:127], a[92:95], a[28:31], v[112:127]
  s_add_u32 s16, s16, 4096
  s_sub_u32 s16, s16, s89
  buffer_load_dwordx4 a[0:3], v219, s[36:39], s16 offen offset:0 sc1
  buffer_load_dwordx4 a[4:7], v220, s[36:39], s16 offen offset:0 sc1
  v_mfma_f32_32x32x16_bf16 v[80:95], a[88:91], a[28:31], v[80:95]
  ds_read_b64_tr_b16 a[160:161], v63 offset:32256
  ds_read_b64_tr_b16 a[162:163], v63 offset:33280
  ds_read_b64_tr_b16 a[164:165], v216 offset:32256
  ds_read_b64_tr_b16 a[166:167], v216 offset:33280
  ds_read_b64_tr_b16 a[168:169], v63 offset:34304
  ds_read_b64_tr_b16 a[170:171], v217 offset:35328
  ds_read_b64_tr_b16 a[172:173], v216 offset:34304
  v_mfma_f32_32x32x16_bf16 v[96:111], a[92:95], a[24:27], v[96:111]
  ds_read_b64_tr_b16 a[174:175], v218 offset:35328
  ds_read_b64_tr_b16 a[176:177], v63 offset:0
  ds_read_b64_tr_b16 a[178:179], v63 offset:1024
  ds_read_b64_tr_b16 a[180:181], v216 offset:0
  ds_read_b64_tr_b16 a[182:183], v216 offset:1024
  ds_read_b64_tr_b16 a[184:185], v63 offset:2048
  ds_read_b64_tr_b16 a[186:187], v217 offset:3072
  ds_read_b64_tr_b16 a[188:189], v216 offset:2048
  ds_read_b64_tr_b16 a[190:191], v218 offset:3072
  v_mfma_f32_32x32x16_bf16 v[64:79], a[88:91], a[24:27], v[64:79]
  ds_read_b64_tr_b16 a[192:193], v63 offset:3584
  ds_read_b64_tr_b16 a[194:195], v63 offset:4608
  ds_read_b64_tr_b16 a[196:197], v216 offset:3584
  ds_read_b64_tr_b16 a[198:199], v216 offset:4608
  ds_read_b64_tr_b16 a[200:201], v63 offset:5632
  ds_read_b64_tr_b16 a[202:203], v217 offset:6656
  ds_read_b64_tr_b16 a[204:205], v216 offset:5632
  ds_read_b64_tr_b16 a[206:207], v218 offset:6656
  s_waitcnt vmcnt(8)
  v_mfma_f32_32x32x16_bf16 v[112:127], a[100:103], a[36:39], v[112:127]
  s_waitcnt lgkmcnt(0)
  buffer_load_dwordx4 a[8:11], v219, s[36:39], s16 offen offset:1024 sc1
  v_mfma_f32_32x32x16_bf16 v[80:95], a[96:99], a[36:39], v[80:95]
  v_mfma_f32_32x32x16_bf16 v[96:111], a[100:103], a[32:35], v[96:111]
  buffer_load_dwordx4 a[12:15], v220, s[36:39], s16 offen offset:1024 sc1
  v_mfma_f32_32x32x16_bf16 v[64:79], a[96:99], a[32:35], v[64:79]
  s_waitcnt vmcnt(8)
  v_mfma_f32_32x32x16_bf16 v[112:127], a[108:111], a[44:47], v[112:127]
  buffer_load_dwordx4 a[16:19], v219, s[36:39], s16 offen offset:2048 sc1
  v_mfma_f32_32x32x16_bf16 v[80:95], a[104:107], a[44:47], v[80:95]
  v_mfma_f32_32x32x16_bf16 v[96:111], a[108:111], a[40:43], v[96:111]
  buffer_load_dwordx4 a[20:23], v220, s[36:39], s16 offen offset:2048 sc1
  v_mfma_f32_32x32x16_bf16 v[64:79], a[104:107], a[40:43], v[64:79]
  s_waitcnt vmcnt(8)
  v_mfma_f32_32x32x16_bf16 v[112:127], a[164:167], a[52:55], v[112:127]
  buffer_load_dwordx4 a[24:27], v219, s[36:39], s16 offen offset:3072 sc1
  v_mfma_f32_32x32x16_bf16 v[80:95], a[160:163], a[52:55], v[80:95]
  v_mfma_f32_32x32x16_bf16 v[96:111], a[164:167], a[48:51], v[96:111]
  buffer_load_dwordx4 a[28:31], v220, s[36:39], s16 offen offset:3072 sc1
  v_mfma_f32_32x32x16_bf16 v[64:79], a[160:163], a[48:51], v[64:79]
  s_waitcnt vmcnt(8)
  v_mfma_f32_32x32x16_bf16 v[112:127], a[172:175], a[60:63], v[112:127]
  v_mfma_f32_32x32x16_bf16 v[80:95], a[168:171], a[60:63], v[80:95]
  v_mfma_f32_32x32x16_bf16 v[96:111], a[172:175], a[56:59], v[96:111]
  v_mfma_f32_32x32x16_bf16 v[64:79], a[168:171], a[56:59], v[64:79]
  s_waitcnt vmcnt(6)
  v_mfma_f32_32x32x16_bf16 v[112:127], a[180:183], a[4:7], v[112:127]
  s_waitcnt vmcnt(4)
  v_mfma_f32_32x32x16_bf16 v[112:127], a[188:191], a[12:15], v[112:127]
  s_waitcnt vmcnt(2)
  v_mfma_f32_32x32x16_bf16 v[112:127], a[196:199], a[20:23], v[112:127]
  s_waitcnt vmcnt(0)
  v_mfma_f32_32x32x16_bf16 v[112:127], a[204:207], a[28:31], v[112:127]
  v_mfma_f32_32x32x16_bf16 v[80:95], a[176:179], a[4:7], v[80:95]
  v_mfma_f32_32x32x16_bf16 v[80:95], a[184:187], a[12:15], v[80:95]
  v_xor_b32 v13, 128, v11
  v_mfma_f32_32x32x16_bf16 v[80:95], a[192:195], a[20:23], v[80:95]
  s_nop 7
  ds_write_b128 v13, v[112:115]
  v_xor_b32 v12, 160, v11
  v_mfma_f32_32x32x16_bf16 v[80:95], a[200:203], a[28:31], v[80:95]
  ds_write_b128 v12, v[116:119]
  v_xor_b32 v13, 192, v11
  ds_write_b128 v13, v[120:123]
  v_mfma_f32_32x32x16_bf16 v[96:111], a[180:183], a[0:3], v[96:111]
  v_xor_b32 v12, 224, v11
  ds_write_b128 v12, v[124:127]
  v_mfma_f32_32x32x16_bf16 v[96:111], a[188:191], a[8:11], v[96:111]
  s_nop 4
  ds_write_b128 v11, v[80:83]
  v_mfma_f32_32x32x16_bf16 v[96:111], a[196:199], a[16:19], v[96:111]
  v_xor_b32 v12, 32, v11
  ds_write_b128 v12, v[84:87]
  v_mfma_f32_32x32x16_bf16 v[96:111], a[204:207], a[24:27], v[96:111]
  v_xor_b32 v13, 64, v11
  ds_write_b128 v13, v[88:91]
  v_mfma_f32_32x32x16_bf16 v[64:79], a[176:179], a[0:3], v[64:79]
  v_xor_b32 v12, 96, v11
  ds_write_b128 v12, v[92:95]
  v_mfma_f32_32x32x16_bf16 v[64:79], a[184:187], a[8:11], v[64:79]
  v_xor_b32 v13, 128, v10
  v_mfma_f32_32x32x16_bf16 v[64:79], a[192:195], a[16:19], v[64:79]
  s_nop 3
  ds_write_b128 v13, v[96:99]
  v_xor_b32 v12, 160, v10
  v_mfma_f32_32x32x16_bf16 v[64:79], a[200:203], a[24:27], v[64:79]
  ds_write_b128 v12, v[100:103]
  v_xor_b32 v13, 192, v10
  ds_write_b128 v13, v[104:107]
  v_xor_b32 v12, 224, v10
  ds_write_b128 v12, v[108:111]
  s_nop 6
  ds_write_b128 v10, v[64:67]
  v_xor_b32 v12, 32, v10
  ds_write_b128 v12, v[68:71]
  v_xor_b32 v13, 64, v10
  ds_write_b128 v13, v[72:75]
  v_xor_b32 v12, 96, v10
  ds_write_b128 v12, v[76:79]
  s_waitcnt lgkmcnt(0)
  s_barrier
  ds_read_b128 v[64:67], v232 offset:0
  ds_read_b128 v[68:71], v233 offset:0
  ds_read_b128 v[72:75], v236 offset:0
  ds_read_b128 v[76:79], v237 offset:0
  ds_read_b128 v[80:83], v240 offset:0
  ds_read_b128 v[84:87], v241 offset:0
  ds_read_b128 v[88:91], v244 offset:0
  ds_read_b128 v[92:95], v245 offset:0
  ds_read_b128 v[96:99], v234 offset:2048
  ds_read_b128 v[100:103], v235 offset:2048
  ds_read_b128 v[104:107], v238 offset:2048
  ds_read_b128 v[108:111], v239 offset:2048
  ds_read_b128 v[112:115], v242 offset:2048
  ds_read_b128 v[116:119], v243 offset:2048
  ds_read_b128 v[120:123], v246 offset:2048
  ds_read_b128 v[124:127], v247 offset:2048
  s_waitcnt lgkmcnt(13)
  v_pk_add_f32 v[64:65], v[64:65], v[72:73]
  v_pk_add_f32 v[66:67], v[66:67], v[74:75]
  s_waitcnt lgkmcnt(12)
  v_pk_add_f32 v[68:69], v[68:69], v[76:77]
  v_pk_add_f32 v[70:71], v[70:71], v[78:79]
  s_waitcnt lgkmcnt(9)
  v_pk_add_f32 v[80:81], v[80:81], v[88:89]
  v_pk_add_f32 v[82:83], v[82:83], v[90:91]
  s_waitcnt lgkmcnt(8)
  v_pk_add_f32 v[84:85], v[84:85], v[92:93]
  v_pk_add_f32 v[86:87], v[86:87], v[94:95]
  v_pk_add_f32 v[64:65], v[64:65], v[80:81]
  v_pk_add_f32 v[66:67], v[66:67], v[82:83]
  v_pk_add_f32 v[68:69], v[68:69], v[84:85]
  v_pk_add_f32 v[70:71], v[70:71], v[86:87]
  v_pk_mul_f32 v[64:65], v[64:65], v[8:9] op_sel:[0,0] op_sel_hi:[1,0]
  v_pk_mul_f32 v[66:67], v[66:67], v[8:9] op_sel:[0,0] op_sel_hi:[1,0]
  v_pk_mul_f32 v[68:69], v[68:69], v[8:9] op_sel:[0,0] op_sel_hi:[1,0]
  v_pk_mul_f32 v[70:71], v[70:71], v[8:9] op_sel:[0,0] op_sel_hi:[1,0]
  v_cvt_pk_bf16_f32 v72, v64, v65
  v_cvt_pk_bf16_f32 v73, v66, v67
  v_cvt_pk_bf16_f32 v74, v68, v69
  v_cvt_pk_bf16_f32 v75, v70, v71
  buffer_store_dwordx4 v[72:75], v14, s[52:55], s76 offen sc0 sc1
  s_waitcnt lgkmcnt(5)
  v_pk_add_f32 v[96:97], v[96:97], v[104:105]
  v_pk_add_f32 v[98:99], v[98:99], v[106:107]
  s_waitcnt lgkmcnt(4)
  v_pk_add_f32 v[100:101], v[100:101], v[108:109]
  v_pk_add_f32 v[102:103], v[102:103], v[110:111]
  s_waitcnt lgkmcnt(1)
  v_pk_add_f32 v[112:113], v[112:113], v[120:121]
  v_pk_add_f32 v[114:115], v[114:115], v[122:123]
  s_waitcnt lgkmcnt(0)
  v_pk_add_f32 v[116:117], v[116:117], v[124:125]
  v_pk_add_f32 v[118:119], v[118:119], v[126:127]
  v_pk_add_f32 v[96:97], v[96:97], v[112:113]
  v_pk_add_f32 v[98:99], v[98:99], v[114:115]
  v_pk_add_f32 v[100:101], v[100:101], v[116:117]
  v_pk_add_f32 v[102:103], v[102:103], v[118:119]
  v_pk_mul_f32 v[96:97], v[96:97], v[8:9] op_sel:[0,1] op_sel_hi:[1,1]
  v_pk_mul_f32 v[98:99], v[98:99], v[8:9] op_sel:[0,1] op_sel_hi:[1,1]
  v_pk_mul_f32 v[100:101], v[100:101], v[8:9] op_sel:[0,1] op_sel_hi:[1,1]
  v_pk_mul_f32 v[102:103], v[102:103], v[8:9] op_sel:[0,1] op_sel_hi:[1,1]
  v_cvt_pk_bf16_f32 v104, v96, v97
  v_cvt_pk_bf16_f32 v105, v98, v99
  v_cvt_pk_bf16_f32 v106, v100, v101
  v_cvt_pk_bf16_f32 v107, v102, v103
  buffer_store_dwordx4 v[104:107], v14, s[52:55], s77 offen sc0 sc1
  s_endpgm
L_make:
  s_add_u32 s76, s26, 12976128
  s_addc_u32 s77, s27, 0
  s_load_dwordx2 s[78:79], s[76:77], 0
  v_mov_b32 v11, 0
  s_waitcnt lgkmcnt(0)
  s_add_u32 s78, s78, 0x9e3779b9
  s_cmp_eq_u32 s78, 0
  s_cselect_b32 s78, 1, s78
  v_mov_b32 v12, s78
  v_mov_b32 v13, s79
  s_mov_b64 exec, 1
  global_store_dwordx2 v11, v[12:13], s[24:25] sc0 sc1
  global_store_dwordx2 v11, v[12:13], s[76:77] sc0 sc1
  s_mov_b64 exec, -1
  s_branch L_make_back
L_nonce1:
  s_mov_b32 s96, 0
L_nonce1_loop:
  global_load_dwordx2 v[46:47], v48, s[24:25] sc1
  s_add_u32 s96, s96, 1
  s_waitcnt vmcnt(0)
  v_cmp_eq_u32 vcc, 0, v46
  s_cmp_lt_u32 s96, 0x80000
  s_cbranch_vccz L_nonce1_back
  s_cbranch_scc1 L_nonce1_loop
  s_branch L_nonce1_back
L_idle:
  s_nop 7
  s_nop 4
  v_pk_mul_f32 v[192:193], v[96:97], s[90:91]
  v_pk_mul_f32 v[194:195], v[98:99], s[90:91]
  v_exp_f32 v192, v192
  v_exp_f32 v193, v193
  v_exp_f32 v194, v194
  v_exp_f32 v195, v195
  v_pk_fma_f32 v[192:193], v[192:193], v[14:15], v[14:15]
  v_pk_fma_f32 v[194:195], v[194:195], v[14:15], v[14:15]
  v_pk_fma_f32 v[192:193], v[192:193], v[192:193], 0.5 op_sel_hi:[1,1,0]
  v_pk_fma_f32 v[194:195], v[194:195], v[194:195], 0.5 op_sel_hi:[1,1,0]
  v_rcp_f32 v192, v192
  v_rcp_f32 v193, v193
  v_rcp_f32 v194, v194
  v_rcp_f32 v195, v195
  v_pk_fma_f32 v[192:193], v[96:97], v[192:193], v[96:97] neg_lo:[1,0,0] neg_hi:[1,0,0]
  v_pk_fma_f32 v[194:195], v[98:99], v[194:195], v[98:99] neg_lo:[1,0,0] neg_hi:[1,0,0]
  v_cvt_pk_bf16_f32 v200, v192, v193
  v_cvt_pk_bf16_f32 v201, v194, v195
  v_pk_mul_f32 v[196:197], v[100:101], s[90:91]
  v_pk_mul_f32 v[198:199], v[102:103], s[90:91]
  v_exp_f32 v196, v196
  v_exp_f32 v197, v197
  v_exp_f32 v198, v198
  v_exp_f32 v199, v199
  v_pk_fma_f32 v[196:197], v[196:197], v[14:15], v[14:15]
  v_pk_fma_f32 v[198:199], v[198:199], v[14:15], v[14:15]
  v_pk_fma_f32 v[196:197], v[196:197], v[196:197], 0.5 op_sel_hi:[1,1,0]
  v_pk_fma_f32 v[198:199], v[198:199], v[198:199], 0.5 op_sel_hi:[1,1,0]
  v_rcp_f32 v196, v196
  v_rcp_f32 v197, v197
  v_rcp_f32 v198, v198
  v_rcp_f32 v199, v199
  v_pk_fma_f32 v[196:197], v[100:101], v[196:197], v[100:101] neg_lo:[1,0,0] neg_hi:[1,0,0]
  v_pk_fma_f32 v[198:199], v[102:103], v[198:199], v[102:103] neg_lo:[1,0,0] neg_hi:[1,0,0]
  v_cvt_pk_bf16_f32 v202, v196, v197
  v_cvt_pk_bf16_f32 v203, v198, v199
  buffer_store_dwordx4 v[200:203], v44, s[36:39], s15 offen offset:0 sc1
  v_pk_mul_f32 v[192:193], v[104:105], s[90:91]
  v_pk_mul_f32 v[194:195], v[106:107], s[90:91]
  v_exp_f32 v192, v192
  v_exp_f32 v193, v193
  v_exp_f32 v194, v194
  v_exp_f32 v195, v195
  v_pk_fma_f32 v[192:193], v[192:193], v[14:15], v[14:15]
  v_pk_fma_f32 v[194:195], v[194:195], v[14:15], v[14:15]
  v_pk_fma_f32 v[192:193], v[192:193], v[192:193], 0.5 op_sel_hi:[1,1,0]
  v_pk_fma_f32 v[194:195], v[194:195], v[194:195], 0.5 op_sel_hi:[1,1,0]
  v_rcp_f32 v192, v192
  v_rcp_f32 v193, v193
  v_rcp_f32 v194, v194
  v_rcp_f32 v195, v195
  v_pk_fma_f32 v[192:193], v[104:105], v[192:193], v[104:105] neg_lo:[1,0,0] neg_hi:[1,0,0]
  v_pk_fma_f32 v[194:195], v[106:107], v[194:195], v[106:107] neg_lo:[1,0,0] neg_hi:[1,0,0]
  v_cvt_pk_bf16_f32 v204, v192, v193
  v_cvt_pk_bf16_f32 v205, v194, v195
  v_pk_mul_f32 v[196:197], v[108:109], s[90:91]
  v_pk_mul_f32 v[198:199], v[110:111], s[90:91]
  v_exp_f32 v196, v196
  v_exp_f32 v197, v197
  v_exp_f32 v198, v198
  v_exp_f32 v199, v199
  v_pk_fma_f32 v[196:197], v[196:197], v[14:15], v[14:15]
  v_pk_fma_f32 v[198:199], v[198:199], v[14:15], v[14:15]
  v_pk_fma_f32 v[196:197], v[196:197], v[196:197], 0.5 op_sel_hi:[1,1,0]
  v_pk_fma_f32 v[198:199], v[198:199], v[198:199], 0.5 op_sel_hi:[1,1,0]
  v_rcp_f32 v196, v196
  v_rcp_f32 v197, v197
  v_rcp_f32 v198, v198
  v_rcp_f32 v199, v199
  v_pk_fma_f32 v[196:197], v[108:109], v[196:197], v[108:109] neg_lo:[1,0,0] neg_hi:[1,0,0]
  v_pk_fma_f32 v[198:199], v[110:111], v[198:199], v[110:111] neg_lo:[1,0,0] neg_hi:[1,0,0]
  v_cvt_pk_bf16_f32 v206, v196, v197
  v_cvt_pk_bf16_f32 v207, v198, v199
  buffer_store_dwordx4 v[204:207], v44, s[36:39], s15 offen offset:1024 sc1
  s_add_u32 s82, s100, 13172736
  s_waitcnt vmcnt(0)
  buffer_store_dwordx2 v[46:47], v49, s[36:39], s82 offen sc1
  s_endpgm
L_poll2:
  s_mov_b32 s96, 0
  s_mov_b32 s17, 12713984
L_poll2_loop:
  buffer_load_dwordx2 v[36:37], v230, s[36:39], s17 offen sc1
  s_add_u32 s96, s96, 1
  s_waitcnt vmcnt(0)
  v_cmp_ne_u64 vcc, s[74:75], v[36:37]
  s_cmp_lt_u32 s96, 0x80000
  s_cbranch_vccz L_poll2_back
  s_cbranch_scc1 L_poll2_loop
  s_branch L_poll2_back
L_poll3:
  s_mov_b32 s96, 0
  s_mov_b32 s17, 12910592
L_poll3_loop:
  buffer_load_dwordx2 v[36:37], v230, s[36:39], s17 offen sc1
  s_add_u32 s96, s96, 1
  s_waitcnt vmcnt(0)
  v_cmp_ne_u64 vcc, s[74:75], v[36:37]
  s_cmp_lt_u32 s96, 0x80000
  s_cbranch_vccz L_poll3_back
  s_cbranch_scc1 L_poll3_loop
  s_branch L_poll3_back
L_poll4:
  s_mov_b32 s96, 0
  s_mov_b32 s17, 13107200
L_poll4_loop:
  buffer_load_dwordx2 v[36:37], v230, s[36:39], s17 offen sc1
  s_add_u32 s96, s96, 1
  s_waitcnt vmcnt(0)
  v_cmp_ne_u64 vcc, s[74:75], v[36:37]
  s_cmp_lt_u32 s96, 0x80000
  s_cbranch_vccz L_poll4_back
  s_cbranch_scc1 L_poll4_loop
  s_branch L_poll4_back
L_poll5:
  s_mov_b32 s96, 0
  s_mov_b32 s17, 13172736
L_poll5_loop:
  buffer_load_dwordx2 v[36:37], v230, s[36:39], s17 offen sc1
  s_add_u32 s96, s96, 1
  s_waitcnt vmcnt(0)
  v_cmp_ne_u64 vcc, s[74:75], v[36:37]
  s_cmp_lt_u32 s96, 0x80000
  s_cbranch_vccz L_poll5_back
  s_cbranch_scc1 L_poll5_loop
  s_branch L_poll5_back
L_poll6:
  s_mov_b32 s96, 0
  s_mov_b32 s17, 12845056
L_poll6_loop:
  buffer_load_dwordx2 v[36:37], v230, s[36:39], s17 offen sc1
  s_add_u32 s96, s96, 1
  s_waitcnt vmcnt(0)
  v_cmp_ne_u64 vcc, s[74:75], v[36:37]
  s_cmp_lt_u32 s96, 0x80000
  s_cbranch_vccz L_poll6_back
  s_cbranch_scc1 L_poll6_loop
  s_branch L_poll6_back
L_nonce7:
  s_mov_b32 s96, 0
L_nonce7_loop:
  global_load_dwordx2 v[50:51], v49, s[24:25] sc1
  s_add_u32 s96, s96, 1
  s_waitcnt vmcnt(0)
  v_cmp_eq_u32 vcc, 0, v50
  s_cmp_lt_u32 s96, 0x80000
  s_cbranch_vccz L_nonce7_back
  s_cbranch_scc1 L_nonce7_loop
  s_branch L_nonce7_back
L_poll8:
  s_mov_b32 s96, 0
  s_mov_b32 s17, 12582912
L_poll8_loop:
  buffer_load_dwordx2 v[44:45], v58, s[36:39], s17 offen sc1
  s_add_u32 s96, s96, 1
  s_waitcnt vmcnt(0)
  v_cmp_ne_u64 vcc, s[74:75], v[44:45]
  s_cmp_lt_u32 s96, 0x80000
  s_cbranch_vccz L_poll8_back
  s_cbranch_scc1 L_poll8_loop
  s_branch L_poll8_back
L_poll9:
  s_mov_b32 s96, 0
  s_mov_b32 s17, 12713984
L_poll9_loop:
  buffer_load_dwordx2 v[42:43], v221, s[36:39], s17 offen sc1
  s_add_u32 s96, s96, 1
  s_waitcnt vmcnt(0)
  v_cmp_ne_u64 vcc, s[74:75], v[42:43]
  s_cmp_lt_u32 s96, 0x80000
  s_cbranch_vccz L_poll9_back
  s_cbranch_scc1 L_poll9_loop
  s_branch L_poll9_back
L_poll10:
  s_mov_b32 s96, 0
  s_mov_b32 s17, 12910592
L_poll10_loop:
  buffer_load_dwordx2 v[42:43], v221, s[36:39], s17 offen sc1
  s_add_u32 s96, s96, 1
  s_waitcnt vmcnt(0)
  v_cmp_ne_u64 vcc, s[74:75], v[42:43]
  s_cmp_lt_u32 s96, 0x80000
  s_cbranch_vccz L_poll10_back
  s_cbranch_scc1 L_poll10_loop
  s_branch L_poll10_back
L_poll11:
  s_mov_b32 s96, 0
  s_mov_b32 s17, 12648448
L_poll11_loop:
  buffer_load_dwordx2 v[44:45], v57, s[36:39], s17 offen sc1
  s_add_u32 s96, s96, 1
  s_waitcnt vmcnt(0)
  v_cmp_ne_u64 vcc, s[74:75], v[44:45]
  s_cmp_lt_u32 s96, 0x80000
  s_cbranch_vccz L_poll11_back
  s_cbranch_scc1 L_poll11_loop
  s_branch L_poll11_back
L_poll12:
  s_mov_b32 s96, 0
  s_mov_b32 s17, 13107200
L_poll12_loop:
  buffer_load_dwordx2 v[42:43], v221, s[36:39], s17 offen sc1
  s_add_u32 s96, s96, 1
  s_waitcnt vmcnt(0)
  v_cmp_ne_u64 vcc, s[74:75], v[42:43]
  s_cmp_lt_u32 s96, 0x80000
  s_cbranch_vccz L_poll12_back
  s_cbranch_scc1 L_poll12_loop
  s_branch L_poll12_back
L_poll13:
  s_mov_b32 s96, 0
  s_mov_b32 s17, 13172736
L_poll13_loop:
  buffer_load_dwordx2 v[42:43], v221, s[36:39], s17 offen sc1
  s_add_u32 s96, s96, 1
  s_waitcnt vmcnt(0)
  v_cmp_ne_u64 vcc, s[74:75], v[42:43]
  s_cmp_lt_u32 s96, 0x80000
  s_cbranch_vccz L_poll13_back
  s_cbranch_scc1 L_poll13_loop
  s_branch L_poll13_back
L_poll14:
  s_mov_b32 s96, 0
  s_mov_b32 s17, 12845056
L_poll14_loop:
  buffer_load_dwordx2 v[42:43], v221, s[36:39], s17 offen sc1
  s_add_u32 s96, s96, 1
  s_waitcnt vmcnt(0)
  v_cmp_ne_u64 vcc, s[74:75], v[42:43]
  s_cmp_lt_u32 s96, 0x80000
  s_cbranch_vccz L_poll14_back
  s_cbranch_scc1 L_poll14_loop
  s_branch L_poll14_back
L_end:
  s_endpgm
L_code_end:
.fill 1100, 4, 0xbf800000
.section .rodata,"a"
.p2align 6
.amdhsa_kernel gated_mix__linear_kernel_hedgehog__dense_activation_mish__prompt_kernel
  .amdhsa_next_free_vgpr 512
  .amdhsa_next_free_sgpr 102
  .amdhsa_accum_offset 256
  .amdhsa_group_segment_fixed_size 0
  .amdhsa_kernarg_size 96
  .amdhsa_user_sgpr_count 2
  .amdhsa_user_sgpr_kernarg_segment_ptr 1
  .amdhsa_system_sgpr_workgroup_id_x 1
.end_amdhsa_kernel
```
